```python
import torch

def _softmax(x, axis=-1):
    return torch.softmax(x, dim=axis)
def _gelu(x):
    return torch.nn.functional.gelu(x, approximate="tanh")
def _silu(x):
    return torch.nn.functional.silu(x)
def _sigmoid(x):
    return torch.sigmoid(x)
def _layernorm(x, axis=-1, eps=1e-5):
    m = x.mean(dim=axis, keepdim=True)
    v = x.var(dim=axis, keepdim=True, unbiased=False)
    return (x - m) / torch.sqrt(v + eps)
def _scatter_add(tgt, idx, src, axis=0):
    return tgt.clone().index_add_(axis, idx, src)
def _segment_sum(src, seg, n):
    out = torch.zeros((n,) + src.shape[1:], dtype=src.dtype)
    return out.index_add_(0, seg, src)
def _pad(x, pw):
    flat = tuple(v for pair in reversed(pw) for v in pair)
    return torch.nn.functional.pad(x, flat)

kernel_name = 'gather_scatter__hybrid_graph_tf_graphgps__graph'

def setup_inputs():

    _w = (lambda a: (lambda t: t.to(torch.bfloat16) if t.is_floating_point() else t)(torch.as_tensor(a)))
    N, deg, D = 10000, 64, 64
    E = N * deg
    src = (lambda lo, hi, *s: torch.randint(lo, hi, s))(0, N, E).to(torch.int64)
    dst = (lambda lo, hi, *s: torch.randint(lo, hi, s))(0, N, E).to(torch.int64)
    deg_cnt = torch.bincount(dst, minlength=N).to(float) + 1.0
    sc = 1.0 / float(D) ** 0.5
    return {
        "x": _w((lambda *s: torch.randn(*s, dtype=torch.bfloat16) * 0.05)(N, D)),
        "src": _w(src),
        "dst": _w(dst),
        "deg_inv": _w((1.0 / deg_cnt).to(float)),
        "w_msg": _w((lambda *s: torch.randn(*s, dtype=torch.bfloat16) * 0.4)(D, D) * sc),
        "wq": _w((lambda *s: torch.randn(*s, dtype=torch.bfloat16) * 1.6)(D, D) * sc),
        "wk": _w((lambda *s: torch.randn(*s, dtype=torch.bfloat16) * 1.6)(D, D) * sc),
        "wv": _w((lambda *s: torch.randn(*s, dtype=torch.bfloat16) * 0.2)(D, D) * sc),
        "w_out": _w((lambda *s: torch.randn(*s, dtype=torch.bfloat16) * 0.2)(D, D) * sc),
    }

def reference(x, src, dst, deg_inv, w_msg, wq, wk, wv, w_out):
    N, D = x.shape[0], x.shape[1]
    h = _layernorm(x, axis=-1)
    m_e = torch.einsum('nd,de->ne', h, w_msg)
    h_local = _segment_sum(m_e[src], dst, N) * deg_inv[:, None]
    q = torch.einsum('nd,de->ne', h, wq)
    k = torch.einsum('nd,de->ne', h, wk)
    v = torch.einsum('nd,de->ne', h, wv)
    logits = torch.einsum('id,jd->ij', q, k) / (float(D) ** 0.5)
    attn = _softmax(logits, axis=-1)
    h_global = torch.einsum('ij,jd->id', attn, v)
    y = torch.einsum('nd,de->ne', h_local + h_global, w_out)
    return x + y
```

```asm
; @launch grid=(256,1,1) block=(512,1,1) lds=163840
.amdgcn_target "amdgcn-amd-amdhsa--gfx950"
.text
.p2align 8
.globl gather_scatter__hybrid_graph_tf_graphgps__graph_kernel
.type gather_scatter__hybrid_graph_tf_graphgps__graph_kernel,@function
gather_scatter__hybrid_graph_tf_graphgps__graph_kernel:
    s_cmp_ge_u32 s2, 256
    s_cbranch_scc1 END
    s_load_dwordx2 s[4:5], s[0:1], 88
    v_lshrrev_b32 v1, 6, v0
    v_and_b32 v0, 63, v0
    v_readfirstlane_b32 s3, v1
    s_lshr_b32 s42, s2, 5
    s_lshl_b32 s42, s42, 3
    s_and_b32 s43, s2, 7
    s_add_u32 s42, s42, s43
    s_bfe_u32 s34, s2, 0x20003
    s_lshl2_add_u32 s33, s42, s34
    s_and_b32 s41, s34, 1
    s_lshr_b32 s46, s34, 1
    s_and_b32 s39, s3, 3
    v_lshlrev_b32 v11, 4, v0
    v_mov_b32 v15, 136832
    s_cmp_eq_u32 s33, 252
    s_cbranch_scc0 NOTH
    s_load_dwordx2 s[16:17], s[0:1], 80
    s_memrealtime s[44:45]
    s_movk_i32 s18, 256
    s_mov_b32 s19, 0x20000
    s_cmp_lg_u32 s3, 0
    s_cbranch_scc1 HELP
    s_mov_b64 exec, 1
    s_waitcnt lgkmcnt(0)
    s_mul_i32 s45, s45, 0x9e3779b1
    s_xor_b32 s44, s44, s45
    s_or_b32 s35, s44, 1
    v_mov_b32 v7, s35
    buffer_store_dword v7, off, s[16:19], 0 sc1
    ds_write_b32 v15, v7
    s_mov_b64 exec, -1
    s_branch HELP
NOTH:
    s_cmp_gt_u32 s33, 252
    s_cbranch_scc1 END
    s_cmp_ge_u32 s3, 4
    s_cbranch_scc1 B_MAIN
    s_cmp_eq_u32 s3, 3
    s_cbranch_scc1 A3
    s_load_dwordx2 s[16:17], s[0:1], 0
    v_and_b32 v3, 31, v0
    v_lshrrev_b32 v4, 5, v0
    s_lshr_b32 s42, s3, 1
    s_xor_b32 s42, s33, s42
    s_mul_i32 s42, s42, 40
    s_and_b32 s43, s33, -4
    s_mul_i32 s43, s43, 40
    s_add_u32 s43, s43, 32
    v_lshrrev_b32 v7, 3, v3
    v_and_b32 v8, 7, v3
    v_mad_u32_u24 v8, v7, 40, v8
    s_cmp_eq_u32 s3, 1
    s_cselect_b32 s42, s43, s42
    s_cselect_b64 vcc, -1, 0
    v_cndmask_b32 v8, v3, v8, vcc
    v_add_u32 v8, s42, v8
    v_lshlrev_b32 v5, 7, v8
    v_lshl_add_u32 v5, v4, 4, v5
    s_mov_b32 s18, 1280000
    s_mov_b32 s19, 0x20000
    s_waitcnt lgkmcnt(0)
    buffer_load_dwordx4 v[208:211], v5, s[16:19], 0 offen offset:0
    buffer_load_dwordx4 v[212:215], v5, s[16:19], 0 offen offset:32
    buffer_load_dwordx4 v[216:219], v5, s[16:19], 0 offen offset:64
    buffer_load_dwordx4 v[220:223], v5, s[16:19], 0 offen offset:96
    v_cmp_eq_u32 s[30:31], 1, v4
    s_mov_b32 s32, 0xffff0000
    s_lshl_b32 s42, s3, 12
    s_add_u32 s42, s42, 118784
    v_add_u32 v245, s42, v11
    v_add_u32 v244, 150464, v11
    s_add_u32 s12, s4, 0x290000
    s_addc_u32 s13, s5, 0
    s_mov_b32 s14, 0x14000
    s_mov_b32 s15, 0x20000
    v_mov_b32 v240, 1
    s_load_dwordx2 s[6:7], s[0:1], 0
    s_load_dwordx2 s[28:29], s[0:1], 72
    s_mul_i32 s42, s39, 323584
    s_sub_u32 s10, 1280000, s42
    s_min_u32 s10, s10, 323584
    s_mov_b32 s11, 0x20000
    s_add_u32 s8, s4, s42
    s_addc_u32 s9, s5, 0
    s_mul_i32 s36, s39, 20480
    s_add_u32 s48, s36, 0
    s_add_u32 s49, s36, 4096
    s_add_u32 s50, s36, 8192
    s_add_u32 s51, s36, 12288
    s_add_u32 s52, s36, 16384
    s_lshl_b32 s45, s41, 13
    s_sub_u32 s45, 0x1000, s45
    s_mul_i32 s37, s41, 319488
    s_lshl_b32 s42, s41, 12
    s_sub_u32 s42, 159744, s42
    s_mul_i32 s47, s45, -80
    s_cmp_eq_u32 s46, 0
    s_cselect_b32 s37, s37, s42
    s_cselect_b32 s47, 0, s47
    s_cmp_eq_u32 s34, 3
    s_cselect_b32 s47, 319488, s45
    s_cselect_b32 s53, 0, -1
    v_lshrrev_b32 v18, 4, v0
    v_and_b32 v19, 15, v0
    v_lshlrev_b32 v4, 4, v19
    v_lshl_add_u32 v4, v18, 9, v4
    v_lshlrev_b32 v2, 7, v19
    v_lshl_add_u32 v2, v18, 4, v2
    v_and_b32 v19, 2, v0
    v_lshlrev_b32 v19, 5, v19
    v_xor_b32 v2, v2, v19
    v_and_b32 v19, 8, v0
    v_lshlrev_b32 v3, 2, v19
    v_xor_b32 v2, v2, v3
    v_add_u32 v2, s36, v2
    v_xor_b32 v3, 64, v2
    v_lshlrev_b32 v6, 3, v19
    v_lshl_add_u32 v6, v18, 10, v6
    v_and_b32 v18, 1, v18
    v_lshl_add_u32 v6, v18, 5, v6
    v_bfe_u32 v18, v0, 2, 2
    v_lshl_add_u32 v6, v18, 7, v6
    v_and_b32 v18, 3, v0
    v_lshl_add_u32 v6, v18, 3, v6
    v_add_u32 v6, s36, v6
    v_xor_b32 v7, 32, v6
    v_xor_b32 v8, 64, v6
    v_xor_b32 v9, 96, v6
    v_mov_b32 v10, 0xdddddddd
    v_and_b32 v18, 16, v0
    v_lshlrev_b32 v18, 2, v18
    v_xor_b32 v242, v18, v11
    v_xor_b32 v243, 32, v242
    s_waitcnt lgkmcnt(0)
    v_and_b32 v16, 15, v0
    v_and_b32 v17, 48, v0
    s_lshr_b32 s42, s39, 1
    v_lshl_add_u32 v19, s42, 4, v16
    s_cmp_ge_u32 s3, 4
    s_cselect_b32 s54, 0, 256
    s_lshl_b32 s55, s54, 4
    s_add_u32 s54, s54, 137024
    s_add_u32 s55, s55, 150464
    v_lshl_add_u32 v249, v19, 2, s54
    v_lshl_add_u32 v250, v19, 4, s55
    v_lshl_add_u32 v250, v17, 5, v250
    v_or_b32 v251, 32, v0
    v_lshl_add_u32 v251, v251, 2, v15
    v_and_b32 v18, 7, v16
    v_and_b32 v13, 8, v16
    v_lshl_add_u32 v13, v13, 1, v18
    v_lshl_add_u32 v13, v17, 1, v13
    v_lshlrev_b32 v13, 4, v13
    v_add_u32 v18, 32, v18
    s_cmp_ge_u32 s3, 4
    s_cselect_b64 vcc, -1, 0
    v_cndmask_b32 v16, v19, v18, vcc
    v_lshrrev_b32 v19, 3, v19
    v_cmp_eq_u32 s[54:55], s34, v19
    v_mul_u32_u24 v1, 144, v16
    v_add_u32 v1, v1, v17
    v_add_u32 v1, 131072, v1
    v_lshl_add_u32 v12, v16, 7, v17
    s_andn2_b64 vcc, vcc, s[54:55]
    s_and_b32 s54, s39, 1
    s_mul_i32 s42, s33, 80
    s_add_u32 s42, s42, s54
    s_lshl_b32 s42, s42, 6
    v_add_u32 v12, s42, v12
    v_mov_b32 v18, 0x70000000
    v_cndmask_b32 v12, v12, v18, vcc
    s_lshl_b32 s42, s54, 12
    v_add_u32 v13, s42, v13
    s_lshl_b32 s42, s39, 13
    s_add_u32 s42, s42, 81920
    v_add_u32 v14, s42, v11
    v_add_u32 v14, s42, v4
    s_lshl_b32 s54, s34, 3
    s_lshl_b32 s54, 0xff, s54
    s_mov_b32 s55, s54
    s_mov_b32 s16, s6
    s_mov_b32 s17, s7
    s_mov_b32 s18, 0x138800
    s_mov_b32 s19, 0x20000
    s_add_u32 s20, s4, 0x280000
    s_addc_u32 s21, s5, 0
    s_mov_b32 s22, 0x4000
    s_mov_b32 s23, 0x20000
    s_mov_b32 s24, s28
    s_mov_b32 s25, s29
    s_mov_b32 s26, 0x138800
    s_mov_b32 s27, 0x20000
    s_movk_i32 s61, 0x1000
    s_movk_i32 s62, 0x2000
    s_movk_i32 s63, 0x3000
    v_mov_b64 v[128:129], 0
    v_mov_b64 v[130:131], 0
    v_mov_b64 v[132:133], 0
    v_mov_b64 v[134:135], 0
    v_mov_b64 v[136:137], 0
    v_mov_b64 v[138:139], 0
    v_mov_b64 v[140:141], 0
    v_mov_b64 v[142:143], 0
    v_mov_b64 v[144:145], 0
    v_mov_b64 v[146:147], 0
    v_mov_b64 v[148:149], 0
    v_mov_b64 v[150:151], 0
    v_mov_b64 v[152:153], 0
    v_mov_b64 v[154:155], 0
    v_mov_b64 v[156:157], 0
    v_mov_b64 v[158:159], 0
    v_mov_b64 v[160:161], 0
    v_mov_b64 v[162:163], 0
    v_mov_b64 v[164:165], 0
    v_mov_b64 v[166:167], 0
    v_mov_b64 v[168:169], 0
    v_mov_b64 v[170:171], 0
    v_mov_b64 v[172:173], 0
    v_mov_b64 v[174:175], 0
    v_mov_b64 v[176:177], 0
    v_mov_b64 v[178:179], 0
    v_mov_b64 v[180:181], 0
    v_mov_b64 v[182:183], 0
    v_mov_b64 v[184:185], 0
    v_mov_b64 v[186:187], 0
    v_mov_b64 v[188:189], 0
    v_mov_b64 v[190:191], 0
    s_barrier
    s_waitcnt vmcnt(0)
    v_lshlrev_b32 v96, 16, v208
    v_and_b32 v97, s32, v208
    v_lshlrev_b32 v98, 16, v209
    v_and_b32 v99, s32, v209
    v_lshlrev_b32 v100, 16, v210
    v_and_b32 v101, s32, v210
    v_lshlrev_b32 v102, 16, v211
    v_and_b32 v103, s32, v211
    v_lshlrev_b32 v104, 16, v212
    v_and_b32 v105, s32, v212
    v_lshlrev_b32 v106, 16, v213
    v_and_b32 v107, s32, v213
    v_lshlrev_b32 v108, 16, v214
    v_and_b32 v109, s32, v214
    v_lshlrev_b32 v110, 16, v215
    v_and_b32 v111, s32, v215
    v_lshlrev_b32 v112, 16, v216
    v_and_b32 v113, s32, v216
    v_lshlrev_b32 v114, 16, v217
    v_and_b32 v115, s32, v217
    v_lshlrev_b32 v116, 16, v218
    v_and_b32 v117, s32, v218
    v_lshlrev_b32 v118, 16, v219
    v_and_b32 v119, s32, v219
    v_lshlrev_b32 v120, 16, v220
    v_and_b32 v121, s32, v220
    v_lshlrev_b32 v122, 16, v221
    v_and_b32 v123, s32, v221
    v_lshlrev_b32 v124, 16, v222
    v_and_b32 v125, s32, v222
    v_lshlrev_b32 v126, 16, v223
    v_and_b32 v127, s32, v223
    v_pk_add_f32 v[228:229], v[96:97], v[98:99]
    v_pk_add_f32 v[230:231], v[100:101], v[102:103]
    v_pk_add_f32 v[228:229], v[228:229], v[104:105]
    v_pk_add_f32 v[230:231], v[230:231], v[106:107]
    v_pk_add_f32 v[228:229], v[228:229], v[108:109]
    v_pk_add_f32 v[230:231], v[230:231], v[110:111]
    v_pk_add_f32 v[228:229], v[228:229], v[112:113]
    v_pk_add_f32 v[230:231], v[230:231], v[114:115]
    v_pk_add_f32 v[228:229], v[228:229], v[116:117]
    v_pk_add_f32 v[230:231], v[230:231], v[118:119]
    v_pk_add_f32 v[228:229], v[228:229], v[120:121]
    v_pk_add_f32 v[230:231], v[230:231], v[122:123]
    v_pk_add_f32 v[228:229], v[228:229], v[124:125]
    v_pk_add_f32 v[230:231], v[230:231], v[126:127]
    v_pk_add_f32 v[228:229], v[228:229], v[230:231]
    v_add_f32 v228, v228, v229
    v_mov_b32 v230, v228
    v_mov_b32 v231, v228
    s_nop 1
    v_permlane32_swap_b32 v230, v231
    s_nop 1
    v_add_f32 v228, v230, v231
    v_mul_f32 v228, 0xbc800000, v228
    v_mov_b32 v229, v228
    v_pk_add_f32 v[96:97], v[96:97], v[228:229]
    v_pk_add_f32 v[98:99], v[98:99], v[228:229]
    v_pk_add_f32 v[100:101], v[100:101], v[228:229]
    v_pk_add_f32 v[102:103], v[102:103], v[228:229]
    v_pk_add_f32 v[104:105], v[104:105], v[228:229]
    v_pk_add_f32 v[106:107], v[106:107], v[228:229]
    v_pk_add_f32 v[108:109], v[108:109], v[228:229]
    v_pk_add_f32 v[110:111], v[110:111], v[228:229]
    v_pk_add_f32 v[112:113], v[112:113], v[228:229]
    v_pk_add_f32 v[114:115], v[114:115], v[228:229]
    v_pk_add_f32 v[116:117], v[116:117], v[228:229]
    v_pk_add_f32 v[118:119], v[118:119], v[228:229]
    v_pk_add_f32 v[120:121], v[120:121], v[228:229]
    v_pk_add_f32 v[122:123], v[122:123], v[228:229]
    v_pk_add_f32 v[124:125], v[124:125], v[228:229]
    v_pk_add_f32 v[126:127], v[126:127], v[228:229]
    v_pk_mul_f32 v[228:229], v[96:97], v[96:97]
    v_pk_mul_f32 v[230:231], v[98:99], v[98:99]
    v_pk_fma_f32 v[228:229], v[100:101], v[100:101], v[228:229]
    v_pk_fma_f32 v[230:231], v[102:103], v[102:103], v[230:231]
    v_pk_fma_f32 v[228:229], v[104:105], v[104:105], v[228:229]
    v_pk_fma_f32 v[230:231], v[106:107], v[106:107], v[230:231]
    v_pk_fma_f32 v[228:229], v[108:109], v[108:109], v[228:229]
    v_pk_fma_f32 v[230:231], v[110:111], v[110:111], v[230:231]
    v_pk_fma_f32 v[228:229], v[112:113], v[112:113], v[228:229]
    v_pk_fma_f32 v[230:231], v[114:115], v[114:115], v[230:231]
    v_pk_fma_f32 v[228:229], v[116:117], v[116:117], v[228:229]
    v_pk_fma_f32 v[230:231], v[118:119], v[118:119], v[230:231]
    v_pk_fma_f32 v[228:229], v[120:121], v[120:121], v[228:229]
    v_pk_fma_f32 v[230:231], v[122:123], v[122:123], v[230:231]
    v_pk_fma_f32 v[228:229], v[124:125], v[124:125], v[228:229]
    v_pk_fma_f32 v[230:231], v[126:127], v[126:127], v[230:231]
    v_pk_add_f32 v[228:229], v[228:229], v[230:231]
    v_add_f32 v228, v228, v229
    v_mov_b32 v230, v228
    v_mov_b32 v231, v228
    s_nop 1
    v_permlane32_swap_b32 v230, v231
    s_nop 1
    v_add_f32 v228, v230, v231
    v_mul_f32 v228, 0x3c800000, v228
    v_cvt_pk_bf16_f32 v228, v228, v228
    v_lshlrev_b32 v228, 16, v228
    v_add_f32 v228, 0x3727c5ac, v228
    v_cvt_pk_bf16_f32 v228, v228, v228
    v_lshlrev_b32 v228, 16, v228
    v_sqrt_f32 v228, v228
    s_nop 0
    v_cvt_pk_bf16_f32 v228, v228, v228
    v_lshlrev_b32 v228, 16, v228
    v_rcp_f32 v228, v228
    s_nop 0
    v_mov_b32 v229, v228
    v_pk_mul_f32 v[96:97], v[96:97], v[228:229]
    v_pk_mul_f32 v[98:99], v[98:99], v[228:229]
    v_pk_mul_f32 v[100:101], v[100:101], v[228:229]
    v_pk_mul_f32 v[102:103], v[102:103], v[228:229]
    v_pk_mul_f32 v[104:105], v[104:105], v[228:229]
    v_pk_mul_f32 v[106:107], v[106:107], v[228:229]
    v_pk_mul_f32 v[108:109], v[108:109], v[228:229]
    v_pk_mul_f32 v[110:111], v[110:111], v[228:229]
    v_pk_mul_f32 v[112:113], v[112:113], v[228:229]
    v_pk_mul_f32 v[114:115], v[114:115], v[228:229]
    v_pk_mul_f32 v[116:117], v[116:117], v[228:229]
    v_pk_mul_f32 v[118:119], v[118:119], v[228:229]
    v_pk_mul_f32 v[120:121], v[120:121], v[228:229]
    v_pk_mul_f32 v[122:123], v[122:123], v[228:229]
    v_pk_mul_f32 v[124:125], v[124:125], v[228:229]
    v_pk_mul_f32 v[126:127], v[126:127], v[228:229]
    v_cvt_pk_bf16_f32 v192, v96, v97
    v_cvt_pk_bf16_f32 v193, v98, v99
    v_cvt_pk_bf16_f32 v194, v100, v101
    v_cvt_pk_bf16_f32 v195, v102, v103
    v_cvt_pk_bf16_f32 v196, v104, v105
    v_cvt_pk_bf16_f32 v197, v106, v107
    v_cvt_pk_bf16_f32 v198, v108, v109
    v_cvt_pk_bf16_f32 v199, v110, v111
    v_cvt_pk_bf16_f32 v200, v112, v113
    v_cvt_pk_bf16_f32 v201, v114, v115
    v_cvt_pk_bf16_f32 v202, v116, v117
    v_cvt_pk_bf16_f32 v203, v118, v119
    v_cvt_pk_bf16_f32 v204, v120, v121
    v_cvt_pk_bf16_f32 v205, v122, v123
    v_cvt_pk_bf16_f32 v206, v124, v125
    v_cvt_pk_bf16_f32 v207, v126, v127
    v_mov_b64 v[96:97], 0
    v_mov_b64 v[98:99], 0
    v_mov_b64 v[100:101], 0
    v_mov_b64 v[102:103], 0
    v_mov_b64 v[104:105], 0
    v_mov_b64 v[106:107], 0
    v_mov_b64 v[108:109], 0
    v_mov_b64 v[110:111], 0
    v_mov_b64 v[112:113], 0
    v_mov_b64 v[114:115], 0
    v_mov_b64 v[116:117], 0
    v_mov_b64 v[118:119], 0
    v_mov_b64 v[120:121], 0
    v_mov_b64 v[122:123], 0
    v_mov_b64 v[124:125], 0
    v_mov_b64 v[126:127], 0
    s_mov_b32 s58, 800000
L_WM:
    ds_read_b32 v228, v15 offset:44
    s_waitcnt lgkmcnt(0)
    v_readfirstlane_b32 s57, v228
    s_sub_u32 s58, s58, 1
    s_cbranch_scc1 L_WM_X
    s_cmp_lt_u32 s57, 1
    s_cbranch_scc1 L_WM
L_WM_X:
    ds_read_b128 v[32:35], v244 offset:0
    ds_read_b128 v[36:39], v244 offset:1024
    ds_read_b128 v[40:43], v244 offset:2048
    ds_read_b128 v[44:47], v244 offset:3072
    ds_read_b128 v[48:51], v244 offset:4096
    ds_read_b128 v[52:55], v244 offset:5120
    ds_read_b128 v[56:59], v244 offset:6144
    ds_read_b128 v[60:63], v244 offset:7168
    s_waitcnt lgkmcnt(0)
    v_mfma_f32_32x32x16_bf16 v[64:79], v[32:35], v[192:195], 0
    v_mfma_f32_32x32x16_bf16 v[64:79], v[36:39], v[196:199], v[64:79]
    v_mfma_f32_32x32x16_bf16 v[64:79], v[40:43], v[200:203], v[64:79]
    v_mfma_f32_32x32x16_bf16 v[64:79], v[44:47], v[204:207], v[64:79]
    v_mfma_f32_32x32x16_bf16 v[80:95], v[48:51], v[192:195], 0
    v_mfma_f32_32x32x16_bf16 v[80:95], v[52:55], v[196:199], v[80:95]
    v_mfma_f32_32x32x16_bf16 v[80:95], v[56:59], v[200:203], v[80:95]
    v_mfma_f32_32x32x16_bf16 v[80:95], v[60:63], v[204:207], v[80:95]
    s_nop 3
    s_nop 7
    v_pk_mul_f32 v[228:229], v[64:65], v[64:65]
    v_pk_mul_f32 v[230:231], v[66:67], v[66:67]
    v_pk_fma_f32 v[228:229], v[68:69], v[68:69], v[228:229]
    v_pk_fma_f32 v[230:231], v[70:71], v[70:71], v[230:231]
    v_pk_fma_f32 v[228:229], v[72:73], v[72:73], v[228:229]
    v_pk_fma_f32 v[230:231], v[74:75], v[74:75], v[230:231]
    v_pk_fma_f32 v[228:229], v[76:77], v[76:77], v[228:229]
    v_pk_fma_f32 v[230:231], v[78:79], v[78:79], v[230:231]
    v_pk_fma_f32 v[228:229], v[80:81], v[80:81], v[228:229]
    v_pk_fma_f32 v[230:231], v[82:83], v[82:83], v[230:231]
    v_pk_fma_f32 v[228:229], v[84:85], v[84:85], v[228:229]
    v_pk_fma_f32 v[230:231], v[86:87], v[86:87], v[230:231]
    v_pk_fma_f32 v[228:229], v[88:89], v[88:89], v[228:229]
    v_pk_fma_f32 v[230:231], v[90:91], v[90:91], v[230:231]
    v_pk_fma_f32 v[228:229], v[92:93], v[92:93], v[228:229]
    v_pk_fma_f32 v[230:231], v[94:95], v[94:95], v[230:231]
    v_pk_add_f32 v[228:229], v[228:229], v[230:231]
    v_add_f32 v228, v228, v229
    v_mov_b32 v230, v228
    v_mov_b32 v231, v228
    s_nop 1
    v_permlane32_swap_b32 v230, v231
    s_nop 1
    v_add_f32 v228, v230, v231
    v_sqrt_f32 v228, v228
    v_mov_b32 v230, v95
    v_mov_b32 v231, v95
    s_mov_b32 s42, 0x3e38aa3b
    s_mov_b32 s43, 0x3e38aa3b
    v_permlane32_swap_b32 v230, v231
    v_mul_f32 v228, 0xbfb8aa3b, v228
    v_add_f32 v228, 0x42800000, v228
    v_mul_f32 v230, 0xbe38aa3b, v231
    v_mov_b32 v231, v230
    v_pk_fma_f32 v[64:65], v[64:65], s[42:43], v[230:231]
    v_pk_fma_f32 v[66:67], v[66:67], s[42:43], v[230:231]
    v_pk_fma_f32 v[68:69], v[68:69], s[42:43], v[230:231]
    v_pk_fma_f32 v[70:71], v[70:71], s[42:43], v[230:231]
    v_pk_fma_f32 v[72:73], v[72:73], s[42:43], v[230:231]
    v_pk_fma_f32 v[74:75], v[74:75], s[42:43], v[230:231]
    v_pk_fma_f32 v[76:77], v[76:77], s[42:43], v[230:231]
    v_pk_fma_f32 v[78:79], v[78:79], s[42:43], v[230:231]
    v_pk_fma_f32 v[80:81], v[80:81], s[42:43], v[230:231]
    v_pk_fma_f32 v[82:83], v[82:83], s[42:43], v[230:231]
    v_pk_fma_f32 v[84:85], v[84:85], s[42:43], v[230:231]
    v_pk_fma_f32 v[86:87], v[86:87], s[42:43], v[230:231]
    v_pk_fma_f32 v[88:89], v[88:89], s[42:43], v[230:231]
    v_pk_fma_f32 v[90:91], v[90:91], s[42:43], v[230:231]
    v_pk_fma_f32 v[92:93], v[92:93], s[42:43], v[230:231]
    v_pk_fma_f32 v[94:95], v[94:95], s[42:43], v[230:231]
    v_cndmask_b32 v95, v95, v228, s[30:31]
    v_cvt_pk_bf16_f32 v208, v64, v65
    v_cvt_pk_bf16_f32 v209, v66, v67
    v_cvt_pk_bf16_f32 v210, v68, v69
    v_cvt_pk_bf16_f32 v211, v70, v71
    v_cvt_pk_bf16_f32 v212, v72, v73
    v_cvt_pk_bf16_f32 v213, v74, v75
    v_cvt_pk_bf16_f32 v214, v76, v77
    v_cvt_pk_bf16_f32 v215, v78, v79
    v_cvt_pk_bf16_f32 v216, v80, v81
    v_cvt_pk_bf16_f32 v217, v82, v83
    v_cvt_pk_bf16_f32 v218, v84, v85
    v_cvt_pk_bf16_f32 v219, v86, v87
    v_cvt_pk_bf16_f32 v220, v88, v89
    v_cvt_pk_bf16_f32 v221, v90, v91
    v_cvt_pk_bf16_f32 v222, v92, v93
    v_cvt_pk_bf16_f32 v223, v94, v95
    ds_write_b128 v245, v[208:211] offset:0
    ds_write_b128 v245, v[212:215] offset:1024
    ds_write_b128 v245, v[216:219] offset:2048
    ds_write_b128 v245, v[220:223] offset:3072
    s_mov_b64 exec, 1
    ds_add_u32 v15, v240 offset:24
    s_mov_b64 exec, -1
A_MAIN:
    v_mov_b64 v[48:49], 0
    v_mov_b64 v[50:51], 0
    v_mov_b64 v[52:53], 0
    v_mov_b64 v[54:55], 0
    v_mov_b64 v[56:57], 0
    v_mov_b64 v[58:59], 0
    v_mov_b64 v[60:61], 0
    v_mov_b64 v[62:63], 0
    v_mov_b64 v[80:81], 0
    v_mov_b64 v[82:83], 0
    v_mov_b64 v[84:85], 0
    v_mov_b64 v[86:87], 0
    v_mov_b64 v[88:89], 0
    v_mov_b64 v[90:91], 0
    v_mov_b64 v[92:93], 0
    v_mov_b64 v[94:95], 0
    v_lshlrev_b32 v17, 7, v0
    s_mul_i32 s42, s39, 8064
    s_mov_b32 s58, 800000
A_WQ:
    ds_read_b32 v16, v15 offset:24
    s_waitcnt lgkmcnt(0)
    v_readfirstlane_b32 s57, v16
    s_sub_u32 s58, s58, 1
    s_cbranch_scc1 A_WQ_X
    s_cmp_lt_u32 s57, 3
    s_cbranch_scc1 A_WQ
A_WQ_X:
    s_mov_b32 s58, 800000
A_WF:
    ds_read_b32 v16, v15 offset:0
    s_waitcnt lgkmcnt(0)
    v_readfirstlane_b32 s57, v16
    s_sub_u32 s58, s58, 1
    s_cbranch_scc1 A_WF_X
    s_cmp_lt_u32 s57, 1
    s_cbranch_scc1 A_WF
A_WF_X:
    s_mov_b32 s35, s57
    s_cmp_eq_u32 s3, 3
    s_cselect_b32 exec_hi, 0x1fffffff, -1
    s_mov_b32 s58, 100000
A_PG:
    buffer_load_dword v16, v17, s[12:15], s42 offen offset:0 sc1
    s_waitcnt vmcnt(0)
    v_cmpx_ne_u32 vcc, s35, v16
    s_sub_u32 s58, s58, 1
    s_cbranch_scc1 A_PG_X
    s_cbranch_execnz A_PG
A_PG_X:
    s_mov_b64 exec, -1
    s_setprio 1
    s_mov_b32 m0, s48
    s_nop 0
    buffer_load_dwordx4 v242, s[8:11], s37 offen offset:0 sc1 lds
    buffer_load_dwordx4 v243, s[8:11], s37 offen offset:1024 sc1 lds
    buffer_load_dwordx4 v242, s[8:11], s37 offen offset:2048 sc1 lds
    buffer_load_dwordx4 v243, s[8:11], s37 offen offset:3072 sc1 lds
    s_add_u32 s37, s37, s45
    s_mov_b32 m0, s49
    s_nop 0
    buffer_load_dwordx4 v242, s[8:11], s37 offen offset:0 sc1 lds
    buffer_load_dwordx4 v243, s[8:11], s37 offen offset:1024 sc1 lds
    buffer_load_dwordx4 v242, s[8:11], s37 offen offset:2048 sc1 lds
    buffer_load_dwordx4 v243, s[8:11], s37 offen offset:3072 sc1 lds
    s_add_u32 s37, s37, s45
    v_add_u32 v18, 118784, v4
    ds_read_b128 v[192:195], v18 offset:0
    ds_read_b128 v[196:199], v18 offset:2048
    ds_read_b128 v[200:203], v18 offset:256
    ds_read_b128 v[204:207], v18 offset:2304
    ds_read_b128 v[208:211], v18 offset:4096
    ds_read_b128 v[212:215], v18 offset:6144
    ds_read_b128 v[216:219], v18 offset:4352
    ds_read_b128 v[220:223], v18 offset:6400
    ds_read_b128 v[224:227], v18 offset:8192
    ds_read_b128 v[228:231], v18 offset:10240
    ds_read_b128 v[232:235], v18 offset:8448
    ds_read_b128 v[236:239], v18 offset:10496
    s_waitcnt vmcnt(4)
    ds_read_b128 v[64:67], v2 offset:0
    ds_read_b128 v[68:71], v2 offset:2048
    ds_read_b128 v[72:75], v3 offset:0
    ds_read_b128 v[76:79], v3 offset:2048
    s_mov_b32 m0, s50
    s_nop 0
    buffer_load_dwordx4 v242, s[8:11], s37 offen offset:0 sc1 lds
    buffer_load_dwordx4 v243, s[8:11], s37 offen offset:1024 sc1 lds
    buffer_load_dwordx4 v242, s[8:11], s37 offen offset:2048 sc1 lds
    buffer_load_dwordx4 v243, s[8:11], s37 offen offset:3072 sc1 lds
    s_add_u32 s37, s37, s45
    s_mov_b32 m0, s51
    s_nop 0
    buffer_load_dwordx4 v242, s[8:11], s37 offen offset:0 sc1 lds
    buffer_load_dwordx4 v243, s[8:11], s37 offen offset:1024 sc1 lds
    buffer_load_dwordx4 v242, s[8:11], s37 offen offset:2048 sc1 lds
    buffer_load_dwordx4 v243, s[8:11], s37 offen offset:3072 sc1 lds
    s_add_u32 s37, s37, s45
    s_mov_b32 m0, s52
    s_nop 0
    buffer_load_dwordx4 v242, s[8:11], s37 offen offset:0 sc1 lds
    buffer_load_dwordx4 v243, s[8:11], s37 offen offset:1024 sc1 lds
    buffer_load_dwordx4 v242, s[8:11], s37 offen offset:2048 sc1 lds
    buffer_load_dwordx4 v243, s[8:11], s37 offen offset:3072 sc1 lds
    s_add_u32 s37, s37, s45
    s_mov_b64 exec, 1
    ds_add_u32 v15, v240 offset:40
    s_mov_b64 exec, -1
    s_waitcnt lgkmcnt(0)
    v_mfma_f32_16x16x32_bf16 v[16:19], v[64:67], v[192:195], 0
    v_mfma_f32_16x16x32_bf16 v[24:27], v[64:67], v[200:203], 0
    v_mfma_f32_16x16x32_bf16 v[20:23], v[68:71], v[192:195], 0
    v_mfma_f32_16x16x32_bf16 v[28:31], v[68:71], v[200:203], 0
    v_mfma_f32_16x16x32_bf16 v[16:19], v[72:75], v[196:199], v[16:19]
    v_mfma_f32_16x16x32_bf16 v[24:27], v[72:75], v[204:207], v[24:27]
    v_mfma_f32_16x16x32_bf16 v[20:23], v[76:79], v[196:199], v[20:23]
    v_mfma_f32_16x16x32_bf16 v[28:31], v[76:79], v[204:207], v[28:31]
    s_nop 7
    s_mov_b32 s38, 3
.p2align 6
A_L3:
    v_smfmac_f32_16x16x64_bf16 v[176:179], v[88:91], v[48:55], v10
    v_exp_f32 v16, v16
    v_smfmac_f32_16x16x64_bf16 v[184:187], v[92:95], v[48:55], v10
    v_exp_f32 v17, v17
    v_smfmac_f32_16x16x64_bf16 v[164:167], v[80:83], v[56:63], v10
    ds_read_b64_tr_b16 v[80:81], v6 offset:0
    ds_read_b64_tr_b16 v[82:83], v6 offset:512
    v_exp_f32 v18, v18
    v_smfmac_f32_16x16x64_bf16 v[172:175], v[84:87], v[56:63], v10
    ds_read_b64_tr_b16 v[84:85], v7 offset:0
    ds_read_b64_tr_b16 v[86:87], v7 offset:512
    v_exp_f32 v19, v19
    v_smfmac_f32_16x16x64_bf16 v[180:183], v[88:91], v[56:63], v10
    ds_read_b64_tr_b16 v[88:89], v8 offset:0
    ds_read_b64_tr_b16 v[90:91], v8 offset:512
    v_exp_f32 v20, v20
    v_smfmac_f32_16x16x64_bf16 v[188:191], v[92:95], v[56:63], v10
    ds_read_b64_tr_b16 v[92:93], v9 offset:0
    ds_read_b64_tr_b16 v[94:95], v9 offset:512
    v_exp_f32 v21, v21
    v_mfma_f32_16x16x32_bf16 v[32:35], v[64:67], v[208:211], 0
    v_exp_f32 v22, v22
    v_mfma_f32_16x16x32_bf16 v[40:43], v[64:67], v[216:219], 0
    v_exp_f32 v23, v23
    v_mfma_f32_16x16x32_bf16 v[36:39], v[68:71], v[208:211], 0
    v_exp_f32 v24, v24
    v_mfma_f32_16x16x32_bf16 v[44:47], v[68:71], v[216:219], 0
    v_exp_f32 v25, v25
    v_mfma_f32_16x16x32_bf16 v[32:35], v[72:75], v[212:215], v[32:35]
    v_exp_f32 v26, v26
    v_mfma_f32_16x16x32_bf16 v[40:43], v[72:75], v[220:223], v[40:43]
    v_exp_f32 v27, v27
    v_mfma_f32_16x16x32_bf16 v[36:39], v[76:79], v[212:215], v[36:39]
    v_exp_f32 v28, v28
    v_mfma_f32_16x16x32_bf16 v[44:47], v[76:79], v[220:223], v[44:47]
    s_waitcnt lgkmcnt(0)
    v_exp_f32 v29, v29
    v_smfmac_f32_16x16x64_bf16 v[96:99], v[80:83], v[16:23], v10
    v_exp_f32 v30, v30
    v_smfmac_f32_16x16x64_bf16 v[104:107], v[84:87], v[16:23], v10
    v_exp_f32 v31, v31
    v_smfmac_f32_16x16x64_bf16 v[112:115], v[88:91], v[16:23], v10
    s_mov_b32 m0, s48
    v_exp_f32 v32, v32
    v_smfmac_f32_16x16x64_bf16 v[120:123], v[92:95], v[16:23], v10
    buffer_load_dwordx4 v242, s[8:11], s37 offen offset:0 sc1 lds
    v_exp_f32 v33, v33
    v_smfmac_f32_16x16x64_bf16 v[100:103], v[80:83], v[24:31], v10
    buffer_load_dwordx4 v243, s[8:11], s37 offen offset:1024 sc1 lds
    v_exp_f32 v34, v34
    v_smfmac_f32_16x16x64_bf16 v[108:111], v[84:87], v[24:31], v10
    buffer_load_dwordx4 v242, s[8:11], s37 offen offset:2048 sc1 lds
    v_exp_f32 v35, v35
    v_smfmac_f32_16x16x64_bf16 v[116:119], v[88:91], v[24:31], v10
    buffer_load_dwordx4 v243, s[8:11], s37 offen offset:3072 sc1 lds
    v_exp_f32 v36, v36
    v_smfmac_f32_16x16x64_bf16 v[124:127], v[92:95], v[24:31], v10
    s_add_u32 s37, s37, s45
    s_waitcnt vmcnt(16)
    v_exp_f32 v37, v37
    v_mfma_f32_16x16x32_bf16 v[48:51], v[64:67], v[224:227], 0
    v_exp_f32 v38, v38
    v_mfma_f32_16x16x32_bf16 v[56:59], v[64:67], v[232:235], 0
    v_exp_f32 v39, v39
    v_mfma_f32_16x16x32_bf16 v[52:55], v[68:71], v[224:227], 0
    v_exp_f32 v40, v40
    v_mfma_f32_16x16x32_bf16 v[60:63], v[68:71], v[232:235], 0
    v_exp_f32 v41, v41
    v_mfma_f32_16x16x32_bf16 v[48:51], v[72:75], v[228:231], v[48:51]
    v_exp_f32 v42, v42
    v_mfma_f32_16x16x32_bf16 v[56:59], v[72:75], v[236:239], v[56:59]
    v_exp_f32 v43, v43
    v_mfma_f32_16x16x32_bf16 v[52:55], v[76:79], v[228:231], v[52:55]
    v_exp_f32 v44, v44
    v_mfma_f32_16x16x32_bf16 v[60:63], v[76:79], v[236:239], v[60:63]
    v_exp_f32 v45, v45
    v_smfmac_f32_16x16x64_bf16 v[128:131], v[80:83], v[32:39], v10
    ds_read_b128 v[64:67], v2 offset:4096
    ds_read_b128 v[68:71], v2 offset:6144
    v_exp_f32 v46, v46
    v_smfmac_f32_16x16x64_bf16 v[136:139], v[84:87], v[32:39], v10
    ds_read_b128 v[72:75], v3 offset:4096
    ds_read_b128 v[76:79], v3 offset:6144
    v_exp_f32 v47, v47
    v_smfmac_f32_16x16x64_bf16 v[144:147], v[88:91], v[32:39], v10
    v_exp_f32 v48, v48
    v_smfmac_f32_16x16x64_bf16 v[152:155], v[92:95], v[32:39], v10
    v_exp_f32 v49, v49
    v_smfmac_f32_16x16x64_bf16 v[132:135], v[80:83], v[40:47], v10
    v_exp_f32 v50, v50
    v_smfmac_f32_16x16x64_bf16 v[140:143], v[84:87], v[40:47], v10
    v_exp_f32 v51, v51
    v_smfmac_f32_16x16x64_bf16 v[148:151], v[88:91], v[40:47], v10
    v_exp_f32 v52, v52
    v_smfmac_f32_16x16x64_bf16 v[156:159], v[92:95], v[40:47], v10
    s_waitcnt lgkmcnt(0)
    v_exp_f32 v53, v53
    v_mfma_f32_16x16x32_bf16 v[16:19], v[64:67], v[192:195], 0
    v_exp_f32 v54, v54
    v_mfma_f32_16x16x32_bf16 v[24:27], v[64:67], v[200:203], 0
    v_exp_f32 v55, v55
    v_mfma_f32_16x16x32_bf16 v[20:23], v[68:71], v[192:195], 0
    v_exp_f32 v56, v56
    v_mfma_f32_16x16x32_bf16 v[28:31], v[68:71], v[200:203], 0
    v_exp_f32 v57, v57
    v_mfma_f32_16x16x32_bf16 v[16:19], v[72:75], v[196:199], v[16:19]
    v_exp_f32 v58, v58
    v_mfma_f32_16x16x32_bf16 v[24:27], v[72:75], v[204:207], v[24:27]
    v_exp_f32 v59, v59
    v_mfma_f32_16x16x32_bf16 v[20:23], v[76:79], v[196:199], v[20:23]
    v_exp_f32 v60, v60
    v_mfma_f32_16x16x32_bf16 v[28:31], v[76:79], v[204:207], v[28:31]
    v_exp_f32 v61, v61
    v_smfmac_f32_16x16x64_bf16 v[160:163], v[80:83], v[48:55], v10
    v_exp_f32 v62, v62
    v_smfmac_f32_16x16x64_bf16 v[168:171], v[84:87], v[48:55], v10
    v_exp_f32 v63, v63
    v_smfmac_f32_16x16x64_bf16 v[176:179], v[88:91], v[48:55], v10
    v_exp_f32 v16, v16
    v_smfmac_f32_16x16x64_bf16 v[184:187], v[92:95], v[48:55], v10
    v_exp_f32 v17, v17
    v_smfmac_f32_16x16x64_bf16 v[164:167], v[80:83], v[56:63], v10
    ds_read_b64_tr_b16 v[80:81], v6 offset:4096
    ds_read_b64_tr_b16 v[82:83], v6 offset:4608
    v_exp_f32 v18, v18
    v_smfmac_f32_16x16x64_bf16 v[172:175], v[84:87], v[56:63], v10
    ds_read_b64_tr_b16 v[84:85], v7 offset:4096
    ds_read_b64_tr_b16 v[86:87], v7 offset:4608
    v_exp_f32 v19, v19
    v_smfmac_f32_16x16x64_bf16 v[180:183], v[88:91], v[56:63], v10
    ds_read_b64_tr_b16 v[88:89], v8 offset:4096
    ds_read_b64_tr_b16 v[90:91], v8 offset:4608
    v_exp_f32 v20, v20
    v_smfmac_f32_16x16x64_bf16 v[188:191], v[92:95], v[56:63], v10
    ds_read_b64_tr_b16 v[92:93], v9 offset:4096
    ds_read_b64_tr_b16 v[94:95], v9 offset:4608
    v_exp_f32 v21, v21
    v_mfma_f32_16x16x32_bf16 v[32:35], v[64:67], v[208:211], 0
    v_exp_f32 v22, v22
    v_mfma_f32_16x16x32_bf16 v[40:43], v[64:67], v[216:219], 0
    v_exp_f32 v23, v23
    v_mfma_f32_16x16x32_bf16 v[36:39], v[68:71], v[208:211], 0
    v_exp_f32 v24, v24
    v_mfma_f32_16x16x32_bf16 v[44:47], v[68:71], v[216:219], 0
    v_exp_f32 v25, v25
    v_mfma_f32_16x16x32_bf16 v[32:35], v[72:75], v[212:215], v[32:35]
    v_exp_f32 v26, v26
    v_mfma_f32_16x16x32_bf16 v[40:43], v[72:75], v[220:223], v[40:43]
    v_exp_f32 v27, v27
    v_mfma_f32_16x16x32_bf16 v[36:39], v[76:79], v[212:215], v[36:39]
    v_exp_f32 v28, v28
    v_mfma_f32_16x16x32_bf16 v[44:47], v[76:79], v[220:223], v[44:47]
    s_waitcnt lgkmcnt(0)
    v_exp_f32 v29, v29
    v_smfmac_f32_16x16x64_bf16 v[96:99], v[80:83], v[16:23], v10
    v_exp_f32 v30, v30
    v_smfmac_f32_16x16x64_bf16 v[104:107], v[84:87], v[16:23], v10
    v_exp_f32 v31, v31
    v_smfmac_f32_16x16x64_bf16 v[112:115], v[88:91], v[16:23], v10
    s_mov_b32 m0, s49
    v_exp_f32 v32, v32
    v_smfmac_f32_16x16x64_bf16 v[120:123], v[92:95], v[16:23], v10
    buffer_load_dwordx4 v242, s[8:11], s37 offen offset:0 sc1 lds
    v_exp_f32 v33, v33
    v_smfmac_f32_16x16x64_bf16 v[100:103], v[80:83], v[24:31], v10
    buffer_load_dwordx4 v243, s[8:11], s37 offen offset:1024 sc1 lds
    v_exp_f32 v34, v34
    v_smfmac_f32_16x16x64_bf16 v[108:111], v[84:87], v[24:31], v10
    buffer_load_dwordx4 v242, s[8:11], s37 offen offset:2048 sc1 lds
    v_exp_f32 v35, v35
    v_smfmac_f32_16x16x64_bf16 v[116:119], v[88:91], v[24:31], v10
    buffer_load_dwordx4 v243, s[8:11], s37 offen offset:3072 sc1 lds
    v_exp_f32 v36, v36
    v_smfmac_f32_16x16x64_bf16 v[124:127], v[92:95], v[24:31], v10
    s_add_u32 s37, s37, s45
    s_waitcnt vmcnt(16)
    v_exp_f32 v37, v37
    v_mfma_f32_16x16x32_bf16 v[48:51], v[64:67], v[224:227], 0
    v_exp_f32 v38, v38
    v_mfma_f32_16x16x32_bf16 v[56:59], v[64:67], v[232:235], 0
    v_exp_f32 v39, v39
    v_mfma_f32_16x16x32_bf16 v[52:55], v[68:71], v[224:227], 0
    v_exp_f32 v40, v40
    v_mfma_f32_16x16x32_bf16 v[60:63], v[68:71], v[232:235], 0
    v_exp_f32 v41, v41
    v_mfma_f32_16x16x32_bf16 v[48:51], v[72:75], v[228:231], v[48:51]
    v_exp_f32 v42, v42
    v_mfma_f32_16x16x32_bf16 v[56:59], v[72:75], v[236:239], v[56:59]
    v_exp_f32 v43, v43
    v_mfma_f32_16x16x32_bf16 v[52:55], v[76:79], v[228:231], v[52:55]
    v_exp_f32 v44, v44
    v_mfma_f32_16x16x32_bf16 v[60:63], v[76:79], v[236:239], v[60:63]
    v_exp_f32 v45, v45
    v_smfmac_f32_16x16x64_bf16 v[128:131], v[80:83], v[32:39], v10
    ds_read_b128 v[64:67], v2 offset:8192
    ds_read_b128 v[68:71], v2 offset:10240
    v_exp_f32 v46, v46
    v_smfmac_f32_16x16x64_bf16 v[136:139], v[84:87], v[32:39], v10
    ds_read_b128 v[72:75], v3 offset:8192
    ds_read_b128 v[76:79], v3 offset:10240
    v_exp_f32 v47, v47
    v_smfmac_f32_16x16x64_bf16 v[144:147], v[88:91], v[32:39], v10
    v_exp_f32 v48, v48
    v_smfmac_f32_16x16x64_bf16 v[152:155], v[92:95], v[32:39], v10
    v_exp_f32 v49, v49
    v_smfmac_f32_16x16x64_bf16 v[132:135], v[80:83], v[40:47], v10
    v_exp_f32 v50, v50
    v_smfmac_f32_16x16x64_bf16 v[140:143], v[84:87], v[40:47], v10
    v_exp_f32 v51, v51
    v_smfmac_f32_16x16x64_bf16 v[148:151], v[88:91], v[40:47], v10
    v_exp_f32 v52, v52
    v_smfmac_f32_16x16x64_bf16 v[156:159], v[92:95], v[40:47], v10
    s_waitcnt lgkmcnt(0)
    v_exp_f32 v53, v53
    v_mfma_f32_16x16x32_bf16 v[16:19], v[64:67], v[192:195], 0
    v_exp_f32 v54, v54
    v_mfma_f32_16x16x32_bf16 v[24:27], v[64:67], v[200:203], 0
    v_exp_f32 v55, v55
    v_mfma_f32_16x16x32_bf16 v[20:23], v[68:71], v[192:195], 0
    v_exp_f32 v56, v56
    v_mfma_f32_16x16x32_bf16 v[28:31], v[68:71], v[200:203], 0
    v_exp_f32 v57, v57
    v_mfma_f32_16x16x32_bf16 v[16:19], v[72:75], v[196:199], v[16:19]
    v_exp_f32 v58, v58
    v_mfma_f32_16x16x32_bf16 v[24:27], v[72:75], v[204:207], v[24:27]
    v_exp_f32 v59, v59
    v_mfma_f32_16x16x32_bf16 v[20:23], v[76:79], v[196:199], v[20:23]
    v_exp_f32 v60, v60
    v_mfma_f32_16x16x32_bf16 v[28:31], v[76:79], v[204:207], v[28:31]
    v_exp_f32 v61, v61
    v_smfmac_f32_16x16x64_bf16 v[160:163], v[80:83], v[48:55], v10
    v_exp_f32 v62, v62
    v_smfmac_f32_16x16x64_bf16 v[168:171], v[84:87], v[48:55], v10
    v_exp_f32 v63, v63
    v_smfmac_f32_16x16x64_bf16 v[176:179], v[88:91], v[48:55], v10
    v_exp_f32 v16, v16
    v_smfmac_f32_16x16x64_bf16 v[184:187], v[92:95], v[48:55], v10
    v_exp_f32 v17, v17
    v_smfmac_f32_16x16x64_bf16 v[164:167], v[80:83], v[56:63], v10
    ds_read_b64_tr_b16 v[80:81], v6 offset:8192
    ds_read_b64_tr_b16 v[82:83], v6 offset:8704
    v_exp_f32 v18, v18
    v_smfmac_f32_16x16x64_bf16 v[172:175], v[84:87], v[56:63], v10
    ds_read_b64_tr_b16 v[84:85], v7 offset:8192
    ds_read_b64_tr_b16 v[86:87], v7 offset:8704
    v_exp_f32 v19, v19
    v_smfmac_f32_16x16x64_bf16 v[180:183], v[88:91], v[56:63], v10
    ds_read_b64_tr_b16 v[88:89], v8 offset:8192
    ds_read_b64_tr_b16 v[90:91], v8 offset:8704
    v_exp_f32 v20, v20
    v_smfmac_f32_16x16x64_bf16 v[188:191], v[92:95], v[56:63], v10
    ds_read_b64_tr_b16 v[92:93], v9 offset:8192
    ds_read_b64_tr_b16 v[94:95], v9 offset:8704
    v_exp_f32 v21, v21
    v_mfma_f32_16x16x32_bf16 v[32:35], v[64:67], v[208:211], 0
    v_exp_f32 v22, v22
    v_mfma_f32_16x16x32_bf16 v[40:43], v[64:67], v[216:219], 0
    v_exp_f32 v23, v23
    v_mfma_f32_16x16x32_bf16 v[36:39], v[68:71], v[208:211], 0
    v_exp_f32 v24, v24
    v_mfma_f32_16x16x32_bf16 v[44:47], v[68:71], v[216:219], 0
    v_exp_f32 v25, v25
    v_mfma_f32_16x16x32_bf16 v[32:35], v[72:75], v[212:215], v[32:35]
    v_exp_f32 v26, v26
    v_mfma_f32_16x16x32_bf16 v[40:43], v[72:75], v[220:223], v[40:43]
    v_exp_f32 v27, v27
    v_mfma_f32_16x16x32_bf16 v[36:39], v[76:79], v[212:215], v[36:39]
    v_exp_f32 v28, v28
    v_mfma_f32_16x16x32_bf16 v[44:47], v[76:79], v[220:223], v[44:47]
    s_waitcnt lgkmcnt(0)
    v_exp_f32 v29, v29
    v_smfmac_f32_16x16x64_bf16 v[96:99], v[80:83], v[16:23], v10
    v_exp_f32 v30, v30
    v_smfmac_f32_16x16x64_bf16 v[104:107], v[84:87], v[16:23], v10
    v_exp_f32 v31, v31
    v_smfmac_f32_16x16x64_bf16 v[112:115], v[88:91], v[16:23], v10
    s_mov_b32 m0, s50
    v_exp_f32 v32, v32
    v_smfmac_f32_16x16x64_bf16 v[120:123], v[92:95], v[16:23], v10
    buffer_load_dwordx4 v242, s[8:11], s37 offen offset:0 sc1 lds
    v_exp_f32 v33, v33
    v_smfmac_f32_16x16x64_bf16 v[100:103], v[80:83], v[24:31], v10
    buffer_load_dwordx4 v243, s[8:11], s37 offen offset:1024 sc1 lds
    v_exp_f32 v34, v34
    v_smfmac_f32_16x16x64_bf16 v[108:111], v[84:87], v[24:31], v10
    buffer_load_dwordx4 v242, s[8:11], s37 offen offset:2048 sc1 lds
    v_exp_f32 v35, v35
    v_smfmac_f32_16x16x64_bf16 v[116:119], v[88:91], v[24:31], v10
    buffer_load_dwordx4 v243, s[8:11], s37 offen offset:3072 sc1 lds
    v_exp_f32 v36, v36
    v_smfmac_f32_16x16x64_bf16 v[124:127], v[92:95], v[24:31], v10
    s_add_u32 s37, s37, s45
    s_waitcnt vmcnt(16)
    v_exp_f32 v37, v37
    v_mfma_f32_16x16x32_bf16 v[48:51], v[64:67], v[224:227], 0
    v_exp_f32 v38, v38
    v_mfma_f32_16x16x32_bf16 v[56:59], v[64:67], v[232:235], 0
    v_exp_f32 v39, v39
    v_mfma_f32_16x16x32_bf16 v[52:55], v[68:71], v[224:227], 0
    v_exp_f32 v40, v40
    v_mfma_f32_16x16x32_bf16 v[60:63], v[68:71], v[232:235], 0
    v_exp_f32 v41, v41
    v_mfma_f32_16x16x32_bf16 v[48:51], v[72:75], v[228:231], v[48:51]
    v_exp_f32 v42, v42
    v_mfma_f32_16x16x32_bf16 v[56:59], v[72:75], v[236:239], v[56:59]
    v_exp_f32 v43, v43
    v_mfma_f32_16x16x32_bf16 v[52:55], v[76:79], v[228:231], v[52:55]
    v_exp_f32 v44, v44
    v_mfma_f32_16x16x32_bf16 v[60:63], v[76:79], v[236:239], v[60:63]
    v_exp_f32 v45, v45
    v_smfmac_f32_16x16x64_bf16 v[128:131], v[80:83], v[32:39], v10
    ds_read_b128 v[64:67], v2 offset:12288
    ds_read_b128 v[68:71], v2 offset:14336
    v_exp_f32 v46, v46
    v_smfmac_f32_16x16x64_bf16 v[136:139], v[84:87], v[32:39], v10
    ds_read_b128 v[72:75], v3 offset:12288
    ds_read_b128 v[76:79], v3 offset:14336
    v_exp_f32 v47, v47
    v_smfmac_f32_16x16x64_bf16 v[144:147], v[88:91], v[32:39], v10
    v_exp_f32 v48, v48
    v_smfmac_f32_16x16x64_bf16 v[152:155], v[92:95], v[32:39], v10
    v_exp_f32 v49, v49
    v_smfmac_f32_16x16x64_bf16 v[132:135], v[80:83], v[40:47], v10
    v_exp_f32 v50, v50
    v_smfmac_f32_16x16x64_bf16 v[140:143], v[84:87], v[40:47], v10
    v_exp_f32 v51, v51
    v_smfmac_f32_16x16x64_bf16 v[148:151], v[88:91], v[40:47], v10
    v_exp_f32 v52, v52
    v_smfmac_f32_16x16x64_bf16 v[156:159], v[92:95], v[40:47], v10
    s_waitcnt lgkmcnt(0)
    v_exp_f32 v53, v53
    v_mfma_f32_16x16x32_bf16 v[16:19], v[64:67], v[192:195], 0
    v_exp_f32 v54, v54
    v_mfma_f32_16x16x32_bf16 v[24:27], v[64:67], v[200:203], 0
    v_exp_f32 v55, v55
    v_mfma_f32_16x16x32_bf16 v[20:23], v[68:71], v[192:195], 0
    v_exp_f32 v56, v56
    v_mfma_f32_16x16x32_bf16 v[28:31], v[68:71], v[200:203], 0
    v_exp_f32 v57, v57
    v_mfma_f32_16x16x32_bf16 v[16:19], v[72:75], v[196:199], v[16:19]
    v_exp_f32 v58, v58
    v_mfma_f32_16x16x32_bf16 v[24:27], v[72:75], v[204:207], v[24:27]
    v_exp_f32 v59, v59
    v_mfma_f32_16x16x32_bf16 v[20:23], v[76:79], v[196:199], v[20:23]
    v_exp_f32 v60, v60
    v_mfma_f32_16x16x32_bf16 v[28:31], v[76:79], v[204:207], v[28:31]
    v_exp_f32 v61, v61
    v_smfmac_f32_16x16x64_bf16 v[160:163], v[80:83], v[48:55], v10
    v_exp_f32 v62, v62
    v_smfmac_f32_16x16x64_bf16 v[168:171], v[84:87], v[48:55], v10
    v_exp_f32 v63, v63
    v_smfmac_f32_16x16x64_bf16 v[176:179], v[88:91], v[48:55], v10
    v_exp_f32 v16, v16
    v_smfmac_f32_16x16x64_bf16 v[184:187], v[92:95], v[48:55], v10
    v_exp_f32 v17, v17
    v_smfmac_f32_16x16x64_bf16 v[164:167], v[80:83], v[56:63], v10
    ds_read_b64_tr_b16 v[80:81], v6 offset:12288
    ds_read_b64_tr_b16 v[82:83], v6 offset:12800
    v_exp_f32 v18, v18
    v_smfmac_f32_16x16x64_bf16 v[172:175], v[84:87], v[56:63], v10
    ds_read_b64_tr_b16 v[84:85], v7 offset:12288
    ds_read_b64_tr_b16 v[86:87], v7 offset:12800
    v_exp_f32 v19, v19
    v_smfmac_f32_16x16x64_bf16 v[180:183], v[88:91], v[56:63], v10
    ds_read_b64_tr_b16 v[88:89], v8 offset:12288
    ds_read_b64_tr_b16 v[90:91], v8 offset:12800
    v_exp_f32 v20, v20
    v_smfmac_f32_16x16x64_bf16 v[188:191], v[92:95], v[56:63], v10
    ds_read_b64_tr_b16 v[92:93], v9 offset:12288
    ds_read_b64_tr_b16 v[94:95], v9 offset:12800
    v_exp_f32 v21, v21
    v_mfma_f32_16x16x32_bf16 v[32:35], v[64:67], v[208:211], 0
    v_exp_f32 v22, v22
    v_mfma_f32_16x16x32_bf16 v[40:43], v[64:67], v[216:219], 0
    v_exp_f32 v23, v23
    v_mfma_f32_16x16x32_bf16 v[36:39], v[68:71], v[208:211], 0
    v_exp_f32 v24, v24
    v_mfma_f32_16x16x32_bf16 v[44:47], v[68:71], v[216:219], 0
    v_exp_f32 v25, v25
    v_mfma_f32_16x16x32_bf16 v[32:35], v[72:75], v[212:215], v[32:35]
    v_exp_f32 v26, v26
    v_mfma_f32_16x16x32_bf16 v[40:43], v[72:75], v[220:223], v[40:43]
    v_exp_f32 v27, v27
    v_mfma_f32_16x16x32_bf16 v[36:39], v[76:79], v[212:215], v[36:39]
    v_exp_f32 v28, v28
    v_mfma_f32_16x16x32_bf16 v[44:47], v[76:79], v[220:223], v[44:47]
    s_waitcnt lgkmcnt(0)
    v_exp_f32 v29, v29
    v_smfmac_f32_16x16x64_bf16 v[96:99], v[80:83], v[16:23], v10
    v_exp_f32 v30, v30
    v_smfmac_f32_16x16x64_bf16 v[104:107], v[84:87], v[16:23], v10
    v_exp_f32 v31, v31
    v_smfmac_f32_16x16x64_bf16 v[112:115], v[88:91], v[16:23], v10
    s_mov_b32 m0, s51
    ds_read_b32 v241, v15 offset:36
    v_exp_f32 v32, v32
    v_smfmac_f32_16x16x64_bf16 v[120:123], v[92:95], v[16:23], v10
    buffer_load_dwordx4 v242, s[8:11], s37 offen offset:0 sc1 lds
    v_exp_f32 v33, v33
    v_smfmac_f32_16x16x64_bf16 v[100:103], v[80:83], v[24:31], v10
    buffer_load_dwordx4 v243, s[8:11], s37 offen offset:1024 sc1 lds
    v_exp_f32 v34, v34
    v_smfmac_f32_16x16x64_bf16 v[108:111], v[84:87], v[24:31], v10
    buffer_load_dwordx4 v242, s[8:11], s37 offen offset:2048 sc1 lds
    v_exp_f32 v35, v35
    v_smfmac_f32_16x16x64_bf16 v[116:119], v[88:91], v[24:31], v10
    buffer_load_dwordx4 v243, s[8:11], s37 offen offset:3072 sc1 lds
    v_exp_f32 v36, v36
    v_smfmac_f32_16x16x64_bf16 v[124:127], v[92:95], v[24:31], v10
    s_add_u32 s37, s37, s45
    s_waitcnt vmcnt(16)
    v_exp_f32 v37, v37
    v_mfma_f32_16x16x32_bf16 v[48:51], v[64:67], v[224:227], 0
    v_exp_f32 v38, v38
    v_mfma_f32_16x16x32_bf16 v[56:59], v[64:67], v[232:235], 0
    v_exp_f32 v39, v39
    v_mfma_f32_16x16x32_bf16 v[52:55], v[68:71], v[224:227], 0
    v_exp_f32 v40, v40
    v_mfma_f32_16x16x32_bf16 v[60:63], v[68:71], v[232:235], 0
    v_exp_f32 v41, v41
    v_mfma_f32_16x16x32_bf16 v[48:51], v[72:75], v[228:231], v[48:51]
    v_exp_f32 v42, v42
    v_mfma_f32_16x16x32_bf16 v[56:59], v[72:75], v[236:239], v[56:59]
    v_exp_f32 v43, v43
    v_mfma_f32_16x16x32_bf16 v[52:55], v[76:79], v[228:231], v[52:55]
    v_exp_f32 v44, v44
    v_mfma_f32_16x16x32_bf16 v[60:63], v[76:79], v[236:239], v[60:63]
    v_exp_f32 v45, v45
    v_smfmac_f32_16x16x64_bf16 v[128:131], v[80:83], v[32:39], v10
    ds_read_b128 v[64:67], v2 offset:16384
    ds_read_b128 v[68:71], v2 offset:18432
    v_exp_f32 v46, v46
    v_smfmac_f32_16x16x64_bf16 v[136:139], v[84:87], v[32:39], v10
    ds_read_b128 v[72:75], v3 offset:16384
    ds_read_b128 v[76:79], v3 offset:18432
    v_exp_f32 v47, v47
    v_smfmac_f32_16x16x64_bf16 v[144:147], v[88:91], v[32:39], v10
    v_exp_f32 v48, v48
    v_smfmac_f32_16x16x64_bf16 v[152:155], v[92:95], v[32:39], v10
    v_exp_f32 v49, v49
    v_smfmac_f32_16x16x64_bf16 v[132:135], v[80:83], v[40:47], v10
    v_exp_f32 v50, v50
    v_smfmac_f32_16x16x64_bf16 v[140:143], v[84:87], v[40:47], v10
    v_exp_f32 v51, v51
    v_smfmac_f32_16x16x64_bf16 v[148:151], v[88:91], v[40:47], v10
    v_exp_f32 v52, v52
    v_smfmac_f32_16x16x64_bf16 v[156:159], v[92:95], v[40:47], v10
    s_waitcnt lgkmcnt(0)
    v_exp_f32 v53, v53
    v_mfma_f32_16x16x32_bf16 v[16:19], v[64:67], v[192:195], 0
    v_exp_f32 v54, v54
    v_mfma_f32_16x16x32_bf16 v[24:27], v[64:67], v[200:203], 0
    v_exp_f32 v55, v55
    v_mfma_f32_16x16x32_bf16 v[20:23], v[68:71], v[192:195], 0
    v_exp_f32 v56, v56
    v_mfma_f32_16x16x32_bf16 v[28:31], v[68:71], v[200:203], 0
    v_exp_f32 v57, v57
    v_mfma_f32_16x16x32_bf16 v[16:19], v[72:75], v[196:199], v[16:19]
    v_exp_f32 v58, v58
    v_mfma_f32_16x16x32_bf16 v[24:27], v[72:75], v[204:207], v[24:27]
    v_exp_f32 v59, v59
    v_mfma_f32_16x16x32_bf16 v[20:23], v[76:79], v[196:199], v[20:23]
    v_exp_f32 v60, v60
    v_mfma_f32_16x16x32_bf16 v[28:31], v[76:79], v[204:207], v[28:31]
    v_exp_f32 v61, v61
    v_smfmac_f32_16x16x64_bf16 v[160:163], v[80:83], v[48:55], v10
    v_exp_f32 v62, v62
    v_smfmac_f32_16x16x64_bf16 v[168:171], v[84:87], v[48:55], v10
    v_exp_f32 v63, v63
    v_smfmac_f32_16x16x64_bf16 v[176:179], v[88:91], v[48:55], v10
    s_cmp_eq_u32 s38, s53
    v_exp_f32 v16, v16
    v_smfmac_f32_16x16x64_bf16 v[184:187], v[92:95], v[48:55], v10
    s_cbranch_scc1 A_KE
A_KR:
    v_exp_f32 v17, v17
    v_smfmac_f32_16x16x64_bf16 v[164:167], v[80:83], v[56:63], v10
    ds_read_b64_tr_b16 v[80:81], v6 offset:16384
    ds_read_b64_tr_b16 v[82:83], v6 offset:16896
    v_exp_f32 v18, v18
    v_smfmac_f32_16x16x64_bf16 v[172:175], v[84:87], v[56:63], v10
    ds_read_b64_tr_b16 v[84:85], v7 offset:16384
    ds_read_b64_tr_b16 v[86:87], v7 offset:16896
    v_exp_f32 v19, v19
    v_smfmac_f32_16x16x64_bf16 v[180:183], v[88:91], v[56:63], v10
    ds_read_b64_tr_b16 v[88:89], v8 offset:16384
    ds_read_b64_tr_b16 v[90:91], v8 offset:16896
    v_exp_f32 v20, v20
    v_smfmac_f32_16x16x64_bf16 v[188:191], v[92:95], v[56:63], v10
    ds_read_b64_tr_b16 v[92:93], v9 offset:16384
    ds_read_b64_tr_b16 v[94:95], v9 offset:16896
    v_exp_f32 v21, v21
    v_mfma_f32_16x16x32_bf16 v[32:35], v[64:67], v[208:211], 0
    v_exp_f32 v22, v22
    v_mfma_f32_16x16x32_bf16 v[40:43], v[64:67], v[216:219], 0
    v_exp_f32 v23, v23
    v_mfma_f32_16x16x32_bf16 v[36:39], v[68:71], v[208:211], 0
    v_exp_f32 v24, v24
    v_mfma_f32_16x16x32_bf16 v[44:47], v[68:71], v[216:219], 0
    v_exp_f32 v25, v25
    v_mfma_f32_16x16x32_bf16 v[32:35], v[72:75], v[212:215], v[32:35]
    v_exp_f32 v26, v26
    v_mfma_f32_16x16x32_bf16 v[40:43], v[72:75], v[220:223], v[40:43]
    v_exp_f32 v27, v27
    v_mfma_f32_16x16x32_bf16 v[36:39], v[76:79], v[212:215], v[36:39]
    v_exp_f32 v28, v28
    v_mfma_f32_16x16x32_bf16 v[44:47], v[76:79], v[220:223], v[44:47]
    s_waitcnt lgkmcnt(0)
    v_exp_f32 v29, v29
    v_smfmac_f32_16x16x64_bf16 v[96:99], v[80:83], v[16:23], v10
    v_exp_f32 v30, v30
    v_smfmac_f32_16x16x64_bf16 v[104:107], v[84:87], v[16:23], v10
    v_exp_f32 v31, v31
    v_smfmac_f32_16x16x64_bf16 v[112:115], v[88:91], v[16:23], v10
    s_mov_b32 m0, s52
    v_exp_f32 v32, v32
    v_smfmac_f32_16x16x64_bf16 v[120:123], v[92:95], v[16:23], v10
    buffer_load_dwordx4 v242, s[8:11], s37 offen offset:0 sc1 lds
    v_exp_f32 v33, v33
    v_smfmac_f32_16x16x64_bf16 v[100:103], v[80:83], v[24:31], v10
    buffer_load_dwordx4 v243, s[8:11], s37 offen offset:1024 sc1 lds
    v_exp_f32 v34, v34
    v_smfmac_f32_16x16x64_bf16 v[108:111], v[84:87], v[24:31], v10
    buffer_load_dwordx4 v242, s[8:11], s37 offen offset:2048 sc1 lds
    v_exp_f32 v35, v35
    v_smfmac_f32_16x16x64_bf16 v[116:119], v[88:91], v[24:31], v10
    buffer_load_dwordx4 v243, s[8:11], s37 offen offset:3072 sc1 lds
    v_exp_f32 v36, v36
    v_smfmac_f32_16x16x64_bf16 v[124:127], v[92:95], v[24:31], v10
    s_add_u32 s37, s37, s45
    s_waitcnt vmcnt(16)
    v_exp_f32 v37, v37
    v_mfma_f32_16x16x32_bf16 v[48:51], v[64:67], v[224:227], 0
    v_exp_f32 v38, v38
    v_mfma_f32_16x16x32_bf16 v[56:59], v[64:67], v[232:235], 0
    v_exp_f32 v39, v39
    v_mfma_f32_16x16x32_bf16 v[52:55], v[68:71], v[224:227], 0
    v_exp_f32 v40, v40
    v_mfma_f32_16x16x32_bf16 v[60:63], v[68:71], v[232:235], 0
    v_exp_f32 v41, v41
    v_mfma_f32_16x16x32_bf16 v[48:51], v[72:75], v[228:231], v[48:51]
    v_exp_f32 v42, v42
    v_mfma_f32_16x16x32_bf16 v[56:59], v[72:75], v[236:239], v[56:59]
    v_exp_f32 v43, v43
    v_mfma_f32_16x16x32_bf16 v[52:55], v[76:79], v[228:231], v[52:55]
    v_exp_f32 v44, v44
    v_mfma_f32_16x16x32_bf16 v[60:63], v[76:79], v[236:239], v[60:63]
    v_exp_f32 v45, v45
    v_smfmac_f32_16x16x64_bf16 v[128:131], v[80:83], v[32:39], v10
    ds_read_b128 v[64:67], v2 offset:0
    ds_read_b128 v[68:71], v2 offset:2048
    v_exp_f32 v46, v46
    v_smfmac_f32_16x16x64_bf16 v[136:139], v[84:87], v[32:39], v10
    ds_read_b128 v[72:75], v3 offset:0
    ds_read_b128 v[76:79], v3 offset:2048
    v_exp_f32 v47, v47
    v_smfmac_f32_16x16x64_bf16 v[144:147], v[88:91], v[32:39], v10
    v_exp_f32 v48, v48
    v_smfmac_f32_16x16x64_bf16 v[152:155], v[92:95], v[32:39], v10
    v_exp_f32 v49, v49
    v_smfmac_f32_16x16x64_bf16 v[132:135], v[80:83], v[40:47], v10
    v_exp_f32 v50, v50
    v_smfmac_f32_16x16x64_bf16 v[140:143], v[84:87], v[40:47], v10
    v_exp_f32 v51, v51
    v_smfmac_f32_16x16x64_bf16 v[148:151], v[88:91], v[40:47], v10
    v_exp_f32 v52, v52
    v_smfmac_f32_16x16x64_bf16 v[156:159], v[92:95], v[40:47], v10
    s_waitcnt lgkmcnt(0)
    v_exp_f32 v53, v53
    v_mfma_f32_16x16x32_bf16 v[16:19], v[64:67], v[192:195], 0
    v_exp_f32 v54, v54
    v_mfma_f32_16x16x32_bf16 v[24:27], v[64:67], v[200:203], 0
    v_exp_f32 v55, v55
    v_mfma_f32_16x16x32_bf16 v[20:23], v[68:71], v[192:195], 0
    v_exp_f32 v56, v56
    v_mfma_f32_16x16x32_bf16 v[28:31], v[68:71], v[200:203], 0
    v_exp_f32 v57, v57
    v_mfma_f32_16x16x32_bf16 v[16:19], v[72:75], v[196:199], v[16:19]
    v_exp_f32 v58, v58
    v_mfma_f32_16x16x32_bf16 v[24:27], v[72:75], v[204:207], v[24:27]
    v_exp_f32 v59, v59
    v_mfma_f32_16x16x32_bf16 v[20:23], v[76:79], v[196:199], v[20:23]
    v_exp_f32 v60, v60
    v_mfma_f32_16x16x32_bf16 v[28:31], v[76:79], v[204:207], v[28:31]
    v_exp_f32 v61, v61
    v_smfmac_f32_16x16x64_bf16 v[160:163], v[80:83], v[48:55], v10
    s_sub_u32 s38, s38, 1
    v_exp_f32 v62, v62
    v_smfmac_f32_16x16x64_bf16 v[168:171], v[84:87], v[48:55], v10
    v_exp_f32 v63, v63
    s_cbranch_scc0 A_L3
    v_readfirstlane_b32 s57, v241
    s_cmp_lt_u32 s57, 4
    s_cbranch_scc1 A_WP
A_WPR:
    ds_write_b128 v14, v[128:131] offset:0
    ds_write_b128 v14, v[132:135] offset:256
    ds_write_b128 v14, v[136:139] offset:2048
    ds_write_b128 v14, v[140:143] offset:2304
    ds_write_b128 v14, v[144:147] offset:4096
    ds_write_b128 v14, v[148:151] offset:4352
    ds_write_b128 v14, v[152:155] offset:6144
    ds_write_b128 v14, v[156:159] offset:6400
    s_mov_b64 exec, 1
    ds_add_u32 v15, v240 offset:8
    s_mov_b64 exec, -1
    s_mov_b32 s38, 2
.p2align 6
A_L2:
    v_smfmac_f32_16x16x64_bf16 v[176:179], v[88:91], v[48:55], v10
    s_cmp_eq_u32 s38, 0
    v_exp_f32 v16, v16
    v_smfmac_f32_16x16x64_bf16 v[184:187], v[92:95], v[48:55], v10
    s_cselect_b32 s44, s47, s45
    v_exp_f32 v17, v17
    v_smfmac_f32_16x16x64_bf16 v[164:167], v[80:83], v[56:63], v10
    ds_read_b64_tr_b16 v[80:81], v6 offset:0
    ds_read_b64_tr_b16 v[82:83], v6 offset:512
    v_exp_f32 v18, v18
    v_smfmac_f32_16x16x64_bf16 v[172:175], v[84:87], v[56:63], v10
    ds_read_b64_tr_b16 v[84:85], v7 offset:0
    ds_read_b64_tr_b16 v[86:87], v7 offset:512
    v_exp_f32 v19, v19
    v_smfmac_f32_16x16x64_bf16 v[180:183], v[88:91], v[56:63], v10
    ds_read_b64_tr_b16 v[88:89], v8 offset:0
    ds_read_b64_tr_b16 v[90:91], v8 offset:512
    v_exp_f32 v20, v20
    v_smfmac_f32_16x16x64_bf16 v[188:191], v[92:95], v[56:63], v10
    ds_read_b64_tr_b16 v[92:93], v9 offset:0
    ds_read_b64_tr_b16 v[94:95], v9 offset:512
    v_exp_f32 v21, v21
    v_mfma_f32_16x16x32_bf16 v[48:51], v[64:67], v[224:227], 0
    v_exp_f32 v22, v22
    v_mfma_f32_16x16x32_bf16 v[56:59], v[64:67], v[232:235], 0
    v_exp_f32 v23, v23
    v_mfma_f32_16x16x32_bf16 v[52:55], v[68:71], v[224:227], 0
    v_exp_f32 v24, v24
    v_mfma_f32_16x16x32_bf16 v[60:63], v[68:71], v[232:235], 0
    v_exp_f32 v25, v25
    v_mfma_f32_16x16x32_bf16 v[48:51], v[72:75], v[228:231], v[48:51]
    v_exp_f32 v26, v26
    v_mfma_f32_16x16x32_bf16 v[56:59], v[72:75], v[236:239], v[56:59]
    v_exp_f32 v27, v27
    v_mfma_f32_16x16x32_bf16 v[52:55], v[76:79], v[228:231], v[52:55]
    v_exp_f32 v28, v28
    v_mfma_f32_16x16x32_bf16 v[60:63], v[76:79], v[236:239], v[60:63]
    s_waitcnt vmcnt(12) lgkmcnt(0)
    v_exp_f32 v29, v29
    v_smfmac_f32_16x16x64_bf16 v[96:99], v[80:83], v[16:23], v10
    ds_read_b128 v[64:67], v2 offset:4096
    ds_read_b128 v[68:71], v2 offset:6144
    v_exp_f32 v30, v30
    v_smfmac_f32_16x16x64_bf16 v[104:107], v[84:87], v[16:23], v10
    ds_read_b128 v[72:75], v3 offset:4096
    ds_read_b128 v[76:79], v3 offset:6144
    v_exp_f32 v31, v31
    v_smfmac_f32_16x16x64_bf16 v[112:115], v[88:91], v[16:23], v10
    s_mov_b32 m0, s48
    v_exp_f32 v48, v48
    v_smfmac_f32_16x16x64_bf16 v[120:123], v[92:95], v[16:23], v10
    buffer_load_dwordx4 v242, s[8:11], s37 offen offset:0 sc1 lds
    v_exp_f32 v49, v49
    v_smfmac_f32_16x16x64_bf16 v[100:103], v[80:83], v[24:31], v10
    buffer_load_dwordx4 v243, s[8:11], s37 offen offset:1024 sc1 lds
    v_exp_f32 v50, v50
    v_smfmac_f32_16x16x64_bf16 v[108:111], v[84:87], v[24:31], v10
    buffer_load_dwordx4 v242, s[8:11], s37 offen offset:2048 sc1 lds
    v_exp_f32 v51, v51
    v_smfmac_f32_16x16x64_bf16 v[116:119], v[88:91], v[24:31], v10
    buffer_load_dwordx4 v243, s[8:11], s37 offen offset:3072 sc1 lds
    v_exp_f32 v52, v52
    v_smfmac_f32_16x16x64_bf16 v[124:127], v[92:95], v[24:31], v10
    s_add_u32 s37, s37, s45
    s_waitcnt lgkmcnt(0)
    v_exp_f32 v53, v53
    v_mfma_f32_16x16x32_bf16 v[16:19], v[64:67], v[192:195], 0
    v_exp_f32 v54, v54
    v_mfma_f32_16x16x32_bf16 v[24:27], v[64:67], v[200:203], 0
    v_exp_f32 v55, v55
    v_mfma_f32_16x16x32_bf16 v[20:23], v[68:71], v[192:195], 0
    v_exp_f32 v56, v56
    v_mfma_f32_16x16x32_bf16 v[28:31], v[68:71], v[200:203], 0
    v_exp_f32 v57, v57
    v_mfma_f32_16x16x32_bf16 v[16:19], v[72:75], v[196:199], v[16:19]
    v_exp_f32 v58, v58
    v_mfma_f32_16x16x32_bf16 v[24:27], v[72:75], v[204:207], v[24:27]
    v_exp_f32 v59, v59
    v_mfma_f32_16x16x32_bf16 v[20:23], v[76:79], v[196:199], v[20:23]
    v_exp_f32 v60, v60
    v_mfma_f32_16x16x32_bf16 v[28:31], v[76:79], v[204:207], v[28:31]
    v_exp_f32 v61, v61
    v_smfmac_f32_16x16x64_bf16 v[160:163], v[80:83], v[48:55], v10
    v_exp_f32 v62, v62
    v_smfmac_f32_16x16x64_bf16 v[168:171], v[84:87], v[48:55], v10
    v_exp_f32 v63, v63
    v_smfmac_f32_16x16x64_bf16 v[176:179], v[88:91], v[48:55], v10
    v_exp_f32 v16, v16
    v_smfmac_f32_16x16x64_bf16 v[184:187], v[92:95], v[48:55], v10
    v_exp_f32 v17, v17
    v_smfmac_f32_16x16x64_bf16 v[164:167], v[80:83], v[56:63], v10
    ds_read_b64_tr_b16 v[80:81], v6 offset:4096
    ds_read_b64_tr_b16 v[82:83], v6 offset:4608
    v_exp_f32 v18, v18
    v_smfmac_f32_16x16x64_bf16 v[172:175], v[84:87], v[56:63], v10
    ds_read_b64_tr_b16 v[84:85], v7 offset:4096
    ds_read_b64_tr_b16 v[86:87], v7 offset:4608
    v_exp_f32 v19, v19
    v_smfmac_f32_16x16x64_bf16 v[180:183], v[88:91], v[56:63], v10
    ds_read_b64_tr_b16 v[88:89], v8 offset:4096
    ds_read_b64_tr_b16 v[90:91], v8 offset:4608
    v_exp_f32 v20, v20
    v_smfmac_f32_16x16x64_bf16 v[188:191], v[92:95], v[56:63], v10
    ds_read_b64_tr_b16 v[92:93], v9 offset:4096
    ds_read_b64_tr_b16 v[94:95], v9 offset:4608
    v_exp_f32 v21, v21
    v_mfma_f32_16x16x32_bf16 v[48:51], v[64:67], v[224:227], 0
    v_exp_f32 v22, v22
    v_mfma_f32_16x16x32_bf16 v[56:59], v[64:67], v[232:235], 0
    v_exp_f32 v23, v23
    v_mfma_f32_16x16x32_bf16 v[52:55], v[68:71], v[224:227], 0
    v_exp_f32 v24, v24
    v_mfma_f32_16x16x32_bf16 v[60:63], v[68:71], v[232:235], 0
    v_exp_f32 v25, v25
    v_mfma_f32_16x16x32_bf16 v[48:51], v[72:75], v[228:231], v[48:51]
    v_exp_f32 v26, v26
    v_mfma_f32_16x16x32_bf16 v[56:59], v[72:75], v[236:239], v[56:59]
    v_exp_f32 v27, v27
    v_mfma_f32_16x16x32_bf16 v[52:55], v[76:79], v[228:231], v[52:55]
    v_exp_f32 v28, v28
    v_mfma_f32_16x16x32_bf16 v[60:63], v[76:79], v[236:239], v[60:63]
    s_waitcnt vmcnt(12) lgkmcnt(0)
    v_exp_f32 v29, v29
    v_smfmac_f32_16x16x64_bf16 v[96:99], v[80:83], v[16:23], v10
    ds_read_b128 v[64:67], v2 offset:8192
    ds_read_b128 v[68:71], v2 offset:10240
    v_exp_f32 v30, v30
    v_smfmac_f32_16x16x64_bf16 v[104:107], v[84:87], v[16:23], v10
    ds_read_b128 v[72:75], v3 offset:8192
    ds_read_b128 v[76:79], v3 offset:10240
    v_exp_f32 v31, v31
    v_smfmac_f32_16x16x64_bf16 v[112:115], v[88:91], v[16:23], v10
    s_mov_b32 m0, s49
    v_exp_f32 v48, v48
    v_smfmac_f32_16x16x64_bf16 v[120:123], v[92:95], v[16:23], v10
    buffer_load_dwordx4 v242, s[8:11], s37 offen offset:0 sc1 lds
    v_exp_f32 v49, v49
    v_smfmac_f32_16x16x64_bf16 v[100:103], v[80:83], v[24:31], v10
    buffer_load_dwordx4 v243, s[8:11], s37 offen offset:1024 sc1 lds
    v_exp_f32 v50, v50
    v_smfmac_f32_16x16x64_bf16 v[108:111], v[84:87], v[24:31], v10
    buffer_load_dwordx4 v242, s[8:11], s37 offen offset:2048 sc1 lds
    v_exp_f32 v51, v51
    v_smfmac_f32_16x16x64_bf16 v[116:119], v[88:91], v[24:31], v10
    buffer_load_dwordx4 v243, s[8:11], s37 offen offset:3072 sc1 lds
    v_exp_f32 v52, v52
    v_smfmac_f32_16x16x64_bf16 v[124:127], v[92:95], v[24:31], v10
    s_add_u32 s37, s37, s45
    s_waitcnt lgkmcnt(0)
    v_exp_f32 v53, v53
    v_mfma_f32_16x16x32_bf16 v[16:19], v[64:67], v[192:195], 0
    v_exp_f32 v54, v54
    v_mfma_f32_16x16x32_bf16 v[24:27], v[64:67], v[200:203], 0
    v_exp_f32 v55, v55
    v_mfma_f32_16x16x32_bf16 v[20:23], v[68:71], v[192:195], 0
    v_exp_f32 v56, v56
    v_mfma_f32_16x16x32_bf16 v[28:31], v[68:71], v[200:203], 0
    v_exp_f32 v57, v57
    v_mfma_f32_16x16x32_bf16 v[16:19], v[72:75], v[196:199], v[16:19]
    v_exp_f32 v58, v58
    v_mfma_f32_16x16x32_bf16 v[24:27], v[72:75], v[204:207], v[24:27]
    v_exp_f32 v59, v59
    v_mfma_f32_16x16x32_bf16 v[20:23], v[76:79], v[196:199], v[20:23]
    v_exp_f32 v60, v60
    v_mfma_f32_16x16x32_bf16 v[28:31], v[76:79], v[204:207], v[28:31]
    v_exp_f32 v61, v61
    v_smfmac_f32_16x16x64_bf16 v[160:163], v[80:83], v[48:55], v10
    v_exp_f32 v62, v62
    v_smfmac_f32_16x16x64_bf16 v[168:171], v[84:87], v[48:55], v10
    v_exp_f32 v63, v63
    v_smfmac_f32_16x16x64_bf16 v[176:179], v[88:91], v[48:55], v10
    v_exp_f32 v16, v16
    v_smfmac_f32_16x16x64_bf16 v[184:187], v[92:95], v[48:55], v10
    v_exp_f32 v17, v17
    v_smfmac_f32_16x16x64_bf16 v[164:167], v[80:83], v[56:63], v10
    ds_read_b64_tr_b16 v[80:81], v6 offset:8192
    ds_read_b64_tr_b16 v[82:83], v6 offset:8704
    v_exp_f32 v18, v18
    v_smfmac_f32_16x16x64_bf16 v[172:175], v[84:87], v[56:63], v10
    ds_read_b64_tr_b16 v[84:85], v7 offset:8192
    ds_read_b64_tr_b16 v[86:87], v7 offset:8704
    v_exp_f32 v19, v19
    v_smfmac_f32_16x16x64_bf16 v[180:183], v[88:91], v[56:63], v10
    ds_read_b64_tr_b16 v[88:89], v8 offset:8192
    ds_read_b64_tr_b16 v[90:91], v8 offset:8704
    v_exp_f32 v20, v20
    v_smfmac_f32_16x16x64_bf16 v[188:191], v[92:95], v[56:63], v10
    ds_read_b64_tr_b16 v[92:93], v9 offset:8192
    ds_read_b64_tr_b16 v[94:95], v9 offset:8704
    v_exp_f32 v21, v21
    v_mfma_f32_16x16x32_bf16 v[48:51], v[64:67], v[224:227], 0
    v_exp_f32 v22, v22
    v_mfma_f32_16x16x32_bf16 v[56:59], v[64:67], v[232:235], 0
    v_exp_f32 v23, v23
    v_mfma_f32_16x16x32_bf16 v[52:55], v[68:71], v[224:227], 0
    v_exp_f32 v24, v24
    v_mfma_f32_16x16x32_bf16 v[60:63], v[68:71], v[232:235], 0
    v_exp_f32 v25, v25
    v_mfma_f32_16x16x32_bf16 v[48:51], v[72:75], v[228:231], v[48:51]
    v_exp_f32 v26, v26
    v_mfma_f32_16x16x32_bf16 v[56:59], v[72:75], v[236:239], v[56:59]
    v_exp_f32 v27, v27
    v_mfma_f32_16x16x32_bf16 v[52:55], v[76:79], v[228:231], v[52:55]
    v_exp_f32 v28, v28
    v_mfma_f32_16x16x32_bf16 v[60:63], v[76:79], v[236:239], v[60:63]
    s_waitcnt vmcnt(12) lgkmcnt(0)
    v_exp_f32 v29, v29
    v_smfmac_f32_16x16x64_bf16 v[96:99], v[80:83], v[16:23], v10
    ds_read_b128 v[64:67], v2 offset:12288
    ds_read_b128 v[68:71], v2 offset:14336
    v_exp_f32 v30, v30
    v_smfmac_f32_16x16x64_bf16 v[104:107], v[84:87], v[16:23], v10
    ds_read_b128 v[72:75], v3 offset:12288
    ds_read_b128 v[76:79], v3 offset:14336
    v_exp_f32 v31, v31
    v_smfmac_f32_16x16x64_bf16 v[112:115], v[88:91], v[16:23], v10
    s_mov_b32 m0, s50
    v_exp_f32 v48, v48
    v_smfmac_f32_16x16x64_bf16 v[120:123], v[92:95], v[16:23], v10
    buffer_load_dwordx4 v242, s[8:11], s37 offen offset:0 sc1 lds
    v_exp_f32 v49, v49
    v_smfmac_f32_16x16x64_bf16 v[100:103], v[80:83], v[24:31], v10
    buffer_load_dwordx4 v243, s[8:11], s37 offen offset:1024 sc1 lds
    v_exp_f32 v50, v50
    v_smfmac_f32_16x16x64_bf16 v[108:111], v[84:87], v[24:31], v10
    buffer_load_dwordx4 v242, s[8:11], s37 offen offset:2048 sc1 lds
    v_exp_f32 v51, v51
    v_smfmac_f32_16x16x64_bf16 v[116:119], v[88:91], v[24:31], v10
    buffer_load_dwordx4 v243, s[8:11], s37 offen offset:3072 sc1 lds
    v_exp_f32 v52, v52
    v_smfmac_f32_16x16x64_bf16 v[124:127], v[92:95], v[24:31], v10
    s_add_u32 s37, s37, s45
    s_waitcnt lgkmcnt(0)
    v_exp_f32 v53, v53
    v_mfma_f32_16x16x32_bf16 v[16:19], v[64:67], v[192:195], 0
    v_exp_f32 v54, v54
    v_mfma_f32_16x16x32_bf16 v[24:27], v[64:67], v[200:203], 0
    v_exp_f32 v55, v55
    v_mfma_f32_16x16x32_bf16 v[20:23], v[68:71], v[192:195], 0
    v_exp_f32 v56, v56
    v_mfma_f32_16x16x32_bf16 v[28:31], v[68:71], v[200:203], 0
    v_exp_f32 v57, v57
    v_mfma_f32_16x16x32_bf16 v[16:19], v[72:75], v[196:199], v[16:19]
    v_exp_f32 v58, v58
    v_mfma_f32_16x16x32_bf16 v[24:27], v[72:75], v[204:207], v[24:27]
    v_exp_f32 v59, v59
    v_mfma_f32_16x16x32_bf16 v[20:23], v[76:79], v[196:199], v[20:23]
    v_exp_f32 v60, v60
    v_mfma_f32_16x16x32_bf16 v[28:31], v[76:79], v[204:207], v[28:31]
    v_exp_f32 v61, v61
    v_smfmac_f32_16x16x64_bf16 v[160:163], v[80:83], v[48:55], v10
    v_exp_f32 v62, v62
    v_smfmac_f32_16x16x64_bf16 v[168:171], v[84:87], v[48:55], v10
    v_exp_f32 v63, v63
    v_smfmac_f32_16x16x64_bf16 v[176:179], v[88:91], v[48:55], v10
    v_exp_f32 v16, v16
    v_smfmac_f32_16x16x64_bf16 v[184:187], v[92:95], v[48:55], v10
    v_exp_f32 v17, v17
    v_smfmac_f32_16x16x64_bf16 v[164:167], v[80:83], v[56:63], v10
    ds_read_b64_tr_b16 v[80:81], v6 offset:12288
    ds_read_b64_tr_b16 v[82:83], v6 offset:12800
    v_exp_f32 v18, v18
    v_smfmac_f32_16x16x64_bf16 v[172:175], v[84:87], v[56:63], v10
    ds_read_b64_tr_b16 v[84:85], v7 offset:12288
    ds_read_b64_tr_b16 v[86:87], v7 offset:12800
    v_exp_f32 v19, v19
    v_smfmac_f32_16x16x64_bf16 v[180:183], v[88:91], v[56:63], v10
    ds_read_b64_tr_b16 v[88:89], v8 offset:12288
    ds_read_b64_tr_b16 v[90:91], v8 offset:12800
    v_exp_f32 v20, v20
    v_smfmac_f32_16x16x64_bf16 v[188:191], v[92:95], v[56:63], v10
    ds_read_b64_tr_b16 v[92:93], v9 offset:12288
    ds_read_b64_tr_b16 v[94:95], v9 offset:12800
    v_exp_f32 v21, v21
    v_mfma_f32_16x16x32_bf16 v[48:51], v[64:67], v[224:227], 0
    v_exp_f32 v22, v22
    v_mfma_f32_16x16x32_bf16 v[56:59], v[64:67], v[232:235], 0
    v_exp_f32 v23, v23
    v_mfma_f32_16x16x32_bf16 v[52:55], v[68:71], v[224:227], 0
    v_exp_f32 v24, v24
    v_mfma_f32_16x16x32_bf16 v[60:63], v[68:71], v[232:235], 0
    v_exp_f32 v25, v25
    v_mfma_f32_16x16x32_bf16 v[48:51], v[72:75], v[228:231], v[48:51]
    v_exp_f32 v26, v26
    v_mfma_f32_16x16x32_bf16 v[56:59], v[72:75], v[236:239], v[56:59]
    v_exp_f32 v27, v27
    v_mfma_f32_16x16x32_bf16 v[52:55], v[76:79], v[228:231], v[52:55]
    v_exp_f32 v28, v28
    v_mfma_f32_16x16x32_bf16 v[60:63], v[76:79], v[236:239], v[60:63]
    s_waitcnt vmcnt(12) lgkmcnt(0)
    v_exp_f32 v29, v29
    v_smfmac_f32_16x16x64_bf16 v[96:99], v[80:83], v[16:23], v10
    ds_read_b128 v[64:67], v2 offset:16384
    ds_read_b128 v[68:71], v2 offset:18432
    v_exp_f32 v30, v30
    v_smfmac_f32_16x16x64_bf16 v[104:107], v[84:87], v[16:23], v10
    ds_read_b128 v[72:75], v3 offset:16384
    ds_read_b128 v[76:79], v3 offset:18432
    v_exp_f32 v31, v31
    v_smfmac_f32_16x16x64_bf16 v[112:115], v[88:91], v[16:23], v10
    s_mov_b32 m0, s51
    v_exp_f32 v48, v48
    v_smfmac_f32_16x16x64_bf16 v[120:123], v[92:95], v[16:23], v10
    buffer_load_dwordx4 v242, s[8:11], s37 offen offset:0 sc1 lds
    v_exp_f32 v49, v49
    v_smfmac_f32_16x16x64_bf16 v[100:103], v[80:83], v[24:31], v10
    buffer_load_dwordx4 v243, s[8:11], s37 offen offset:1024 sc1 lds
    v_exp_f32 v50, v50
    v_smfmac_f32_16x16x64_bf16 v[108:111], v[84:87], v[24:31], v10
    buffer_load_dwordx4 v242, s[8:11], s37 offen offset:2048 sc1 lds
    v_exp_f32 v51, v51
    v_smfmac_f32_16x16x64_bf16 v[116:119], v[88:91], v[24:31], v10
    buffer_load_dwordx4 v243, s[8:11], s37 offen offset:3072 sc1 lds
    v_exp_f32 v52, v52
    v_smfmac_f32_16x16x64_bf16 v[124:127], v[92:95], v[24:31], v10
    s_add_u32 s37, s37, s44
    s_waitcnt lgkmcnt(0)
    v_exp_f32 v53, v53
    v_mfma_f32_16x16x32_bf16 v[16:19], v[64:67], v[192:195], 0
    v_exp_f32 v54, v54
    v_mfma_f32_16x16x32_bf16 v[24:27], v[64:67], v[200:203], 0
    v_exp_f32 v55, v55
    v_mfma_f32_16x16x32_bf16 v[20:23], v[68:71], v[192:195], 0
    v_exp_f32 v56, v56
    v_mfma_f32_16x16x32_bf16 v[28:31], v[68:71], v[200:203], 0
    v_exp_f32 v57, v57
    v_mfma_f32_16x16x32_bf16 v[16:19], v[72:75], v[196:199], v[16:19]
    v_exp_f32 v58, v58
    v_mfma_f32_16x16x32_bf16 v[24:27], v[72:75], v[204:207], v[24:27]
    v_exp_f32 v59, v59
    v_mfma_f32_16x16x32_bf16 v[20:23], v[76:79], v[196:199], v[20:23]
    v_exp_f32 v60, v60
    v_mfma_f32_16x16x32_bf16 v[28:31], v[76:79], v[204:207], v[28:31]
    v_exp_f32 v61, v61
    v_smfmac_f32_16x16x64_bf16 v[160:163], v[80:83], v[48:55], v10
    v_exp_f32 v62, v62
    v_smfmac_f32_16x16x64_bf16 v[168:171], v[84:87], v[48:55], v10
    v_exp_f32 v63, v63
    v_smfmac_f32_16x16x64_bf16 v[176:179], v[88:91], v[48:55], v10
    v_exp_f32 v16, v16
    v_smfmac_f32_16x16x64_bf16 v[184:187], v[92:95], v[48:55], v10
    v_exp_f32 v17, v17
    v_smfmac_f32_16x16x64_bf16 v[164:167], v[80:83], v[56:63], v10
    ds_read_b64_tr_b16 v[80:81], v6 offset:16384
    ds_read_b64_tr_b16 v[82:83], v6 offset:16896
    v_exp_f32 v18, v18
    v_smfmac_f32_16x16x64_bf16 v[172:175], v[84:87], v[56:63], v10
    ds_read_b64_tr_b16 v[84:85], v7 offset:16384
    ds_read_b64_tr_b16 v[86:87], v7 offset:16896
    v_exp_f32 v19, v19
    v_smfmac_f32_16x16x64_bf16 v[180:183], v[88:91], v[56:63], v10
    ds_read_b64_tr_b16 v[88:89], v8 offset:16384
    ds_read_b64_tr_b16 v[90:91], v8 offset:16896
    v_exp_f32 v20, v20
    v_smfmac_f32_16x16x64_bf16 v[188:191], v[92:95], v[56:63], v10
    ds_read_b64_tr_b16 v[92:93], v9 offset:16384
    ds_read_b64_tr_b16 v[94:95], v9 offset:16896
    v_exp_f32 v21, v21
    v_mfma_f32_16x16x32_bf16 v[48:51], v[64:67], v[224:227], 0
    v_exp_f32 v22, v22
    v_mfma_f32_16x16x32_bf16 v[56:59], v[64:67], v[232:235], 0
    v_exp_f32 v23, v23
    v_mfma_f32_16x16x32_bf16 v[52:55], v[68:71], v[224:227], 0
    v_exp_f32 v24, v24
    v_mfma_f32_16x16x32_bf16 v[60:63], v[68:71], v[232:235], 0
    v_exp_f32 v25, v25
    v_mfma_f32_16x16x32_bf16 v[48:51], v[72:75], v[228:231], v[48:51]
    v_exp_f32 v26, v26
    v_mfma_f32_16x16x32_bf16 v[56:59], v[72:75], v[236:239], v[56:59]
    v_exp_f32 v27, v27
    v_mfma_f32_16x16x32_bf16 v[52:55], v[76:79], v[228:231], v[52:55]
    v_exp_f32 v28, v28
    v_mfma_f32_16x16x32_bf16 v[60:63], v[76:79], v[236:239], v[60:63]
    s_waitcnt vmcnt(12) lgkmcnt(0)
    v_exp_f32 v29, v29
    v_smfmac_f32_16x16x64_bf16 v[96:99], v[80:83], v[16:23], v10
    ds_read_b128 v[64:67], v2 offset:0
    ds_read_b128 v[68:71], v2 offset:2048
    v_exp_f32 v30, v30
    v_smfmac_f32_16x16x64_bf16 v[104:107], v[84:87], v[16:23], v10
    ds_read_b128 v[72:75], v3 offset:0
    ds_read_b128 v[76:79], v3 offset:2048
    v_exp_f32 v31, v31
    v_smfmac_f32_16x16x64_bf16 v[112:115], v[88:91], v[16:23], v10
    s_mov_b32 m0, s52
    v_exp_f32 v48, v48
    v_smfmac_f32_16x16x64_bf16 v[120:123], v[92:95], v[16:23], v10
    buffer_load_dwordx4 v242, s[8:11], s37 offen offset:0 sc1 lds
    v_exp_f32 v49, v49
    v_smfmac_f32_16x16x64_bf16 v[100:103], v[80:83], v[24:31], v10
    buffer_load_dwordx4 v243, s[8:11], s37 offen offset:1024 sc1 lds
    v_exp_f32 v50, v50
    v_smfmac_f32_16x16x64_bf16 v[108:111], v[84:87], v[24:31], v10
    buffer_load_dwordx4 v242, s[8:11], s37 offen offset:2048 sc1 lds
    v_exp_f32 v51, v51
    v_smfmac_f32_16x16x64_bf16 v[116:119], v[88:91], v[24:31], v10
    buffer_load_dwordx4 v243, s[8:11], s37 offen offset:3072 sc1 lds
    v_exp_f32 v52, v52
    v_smfmac_f32_16x16x64_bf16 v[124:127], v[92:95], v[24:31], v10
    s_add_u32 s37, s37, s45
    s_waitcnt lgkmcnt(0)
    v_exp_f32 v53, v53
    v_mfma_f32_16x16x32_bf16 v[16:19], v[64:67], v[192:195], 0
    v_exp_f32 v54, v54
    v_mfma_f32_16x16x32_bf16 v[24:27], v[64:67], v[200:203], 0
    v_exp_f32 v55, v55
    v_mfma_f32_16x16x32_bf16 v[20:23], v[68:71], v[192:195], 0
    v_exp_f32 v56, v56
    v_mfma_f32_16x16x32_bf16 v[28:31], v[68:71], v[200:203], 0
    v_exp_f32 v57, v57
    v_mfma_f32_16x16x32_bf16 v[16:19], v[72:75], v[196:199], v[16:19]
    v_exp_f32 v58, v58
    v_mfma_f32_16x16x32_bf16 v[24:27], v[72:75], v[204:207], v[24:27]
    v_exp_f32 v59, v59
    v_mfma_f32_16x16x32_bf16 v[20:23], v[76:79], v[196:199], v[20:23]
    v_exp_f32 v60, v60
    v_mfma_f32_16x16x32_bf16 v[28:31], v[76:79], v[204:207], v[28:31]
    v_exp_f32 v61, v61
    v_smfmac_f32_16x16x64_bf16 v[160:163], v[80:83], v[48:55], v10
    s_sub_u32 s38, s38, 1
    v_exp_f32 v62, v62
    v_smfmac_f32_16x16x64_bf16 v[168:171], v[84:87], v[48:55], v10
    v_exp_f32 v63, v63
    s_cbranch_scc0 A_L2
    v_smfmac_f32_16x16x64_bf16 v[176:179], v[88:91], v[48:55], v10
    v_exp_f32 v16, v16
    v_smfmac_f32_16x16x64_bf16 v[184:187], v[92:95], v[48:55], v10
    v_exp_f32 v17, v17
    v_smfmac_f32_16x16x64_bf16 v[164:167], v[80:83], v[56:63], v10
    ds_read_b64_tr_b16 v[80:81], v6 offset:0
    ds_read_b64_tr_b16 v[82:83], v6 offset:512
    v_exp_f32 v18, v18
    v_smfmac_f32_16x16x64_bf16 v[172:175], v[84:87], v[56:63], v10
    ds_read_b64_tr_b16 v[84:85], v7 offset:0
    ds_read_b64_tr_b16 v[86:87], v7 offset:512
    v_exp_f32 v19, v19
    v_smfmac_f32_16x16x64_bf16 v[180:183], v[88:91], v[56:63], v10
    ds_read_b64_tr_b16 v[88:89], v8 offset:0
    ds_read_b64_tr_b16 v[90:91], v8 offset:512
    v_exp_f32 v20, v20
    v_smfmac_f32_16x16x64_bf16 v[188:191], v[92:95], v[56:63], v10
    ds_read_b64_tr_b16 v[92:93], v9 offset:0
    ds_read_b64_tr_b16 v[94:95], v9 offset:512
    s_waitcnt lgkmcnt(8)
    v_exp_f32 v21, v21
    v_mfma_f32_16x16x32_bf16 v[48:51], v[64:67], v[224:227], 0
    v_exp_f32 v22, v22
    v_mfma_f32_16x16x32_bf16 v[56:59], v[64:67], v[232:235], 0
    v_exp_f32 v23, v23
    v_mfma_f32_16x16x32_bf16 v[52:55], v[68:71], v[224:227], 0
    v_exp_f32 v24, v24
    v_mfma_f32_16x16x32_bf16 v[60:63], v[68:71], v[232:235], 0
    v_exp_f32 v25, v25
    v_mfma_f32_16x16x32_bf16 v[48:51], v[72:75], v[228:231], v[48:51]
    v_exp_f32 v26, v26
    v_mfma_f32_16x16x32_bf16 v[56:59], v[72:75], v[236:239], v[56:59]
    v_exp_f32 v27, v27
    v_mfma_f32_16x16x32_bf16 v[52:55], v[76:79], v[228:231], v[52:55]
    v_exp_f32 v28, v28
    v_mfma_f32_16x16x32_bf16 v[60:63], v[76:79], v[236:239], v[60:63]
    s_waitcnt vmcnt(12) lgkmcnt(0)
    v_exp_f32 v29, v29
    v_smfmac_f32_16x16x64_bf16 v[96:99], v[80:83], v[16:23], v10
    ds_read_b128 v[64:67], v2 offset:4096
    ds_read_b128 v[68:71], v2 offset:6144
    v_exp_f32 v30, v30
    v_smfmac_f32_16x16x64_bf16 v[104:107], v[84:87], v[16:23], v10
    ds_read_b128 v[72:75], v3 offset:4096
    ds_read_b128 v[76:79], v3 offset:6144
    v_exp_f32 v31, v31
    v_smfmac_f32_16x16x64_bf16 v[112:115], v[88:91], v[16:23], v10
    v_exp_f32 v48, v48
    v_smfmac_f32_16x16x64_bf16 v[120:123], v[92:95], v[16:23], v10
    v_exp_f32 v49, v49
    v_smfmac_f32_16x16x64_bf16 v[100:103], v[80:83], v[24:31], v10
    v_exp_f32 v50, v50
    v_smfmac_f32_16x16x64_bf16 v[108:111], v[84:87], v[24:31], v10
    v_exp_f32 v51, v51
    v_smfmac_f32_16x16x64_bf16 v[116:119], v[88:91], v[24:31], v10
    v_exp_f32 v52, v52
    v_smfmac_f32_16x16x64_bf16 v[124:127], v[92:95], v[24:31], v10
    s_waitcnt lgkmcnt(0)
    v_exp_f32 v53, v53
    v_mfma_f32_16x16x32_bf16 v[16:19], v[64:67], v[224:227], 0
    v_exp_f32 v54, v54
    v_mfma_f32_16x16x32_bf16 v[24:27], v[64:67], v[232:235], 0
    v_exp_f32 v55, v55
    v_mfma_f32_16x16x32_bf16 v[20:23], v[68:71], v[224:227], 0
    v_exp_f32 v56, v56
    v_mfma_f32_16x16x32_bf16 v[28:31], v[68:71], v[232:235], 0
    v_exp_f32 v57, v57
    v_mfma_f32_16x16x32_bf16 v[16:19], v[72:75], v[228:231], v[16:19]
    v_exp_f32 v58, v58
    v_mfma_f32_16x16x32_bf16 v[24:27], v[72:75], v[236:239], v[24:27]
    v_exp_f32 v59, v59
    v_mfma_f32_16x16x32_bf16 v[20:23], v[76:79], v[228:231], v[20:23]
    v_exp_f32 v60, v60
    v_mfma_f32_16x16x32_bf16 v[28:31], v[76:79], v[236:239], v[28:31]
    s_waitcnt vmcnt(8)
    v_exp_f32 v61, v61
    v_smfmac_f32_16x16x64_bf16 v[160:163], v[80:83], v[48:55], v10
    ds_read_b128 v[64:67], v2 offset:8192
    ds_read_b128 v[68:71], v2 offset:10240
    v_exp_f32 v62, v62
    v_smfmac_f32_16x16x64_bf16 v[168:171], v[84:87], v[48:55], v10
    ds_read_b128 v[72:75], v3 offset:8192
    ds_read_b128 v[76:79], v3 offset:10240
    v_exp_f32 v63, v63
    v_smfmac_f32_16x16x64_bf16 v[176:179], v[88:91], v[48:55], v10
    v_exp_f32 v16, v16
    v_smfmac_f32_16x16x64_bf16 v[184:187], v[92:95], v[48:55], v10
    v_exp_f32 v17, v17
    v_smfmac_f32_16x16x64_bf16 v[164:167], v[80:83], v[56:63], v10
    ds_read_b64_tr_b16 v[80:81], v6 offset:4096
    ds_read_b64_tr_b16 v[82:83], v6 offset:4608
    v_exp_f32 v18, v18
    v_smfmac_f32_16x16x64_bf16 v[172:175], v[84:87], v[56:63], v10
    ds_read_b64_tr_b16 v[84:85], v7 offset:4096
    ds_read_b64_tr_b16 v[86:87], v7 offset:4608
    v_exp_f32 v19, v19
    v_smfmac_f32_16x16x64_bf16 v[180:183], v[88:91], v[56:63], v10
    ds_read_b64_tr_b16 v[88:89], v8 offset:4096
    ds_read_b64_tr_b16 v[90:91], v8 offset:4608
    v_exp_f32 v20, v20
    v_smfmac_f32_16x16x64_bf16 v[188:191], v[92:95], v[56:63], v10
    ds_read_b64_tr_b16 v[92:93], v9 offset:4096
    ds_read_b64_tr_b16 v[94:95], v9 offset:4608
    s_waitcnt lgkmcnt(8)
    v_exp_f32 v21, v21
    v_mfma_f32_16x16x32_bf16 v[48:51], v[64:67], v[224:227], 0
    v_exp_f32 v22, v22
    v_mfma_f32_16x16x32_bf16 v[56:59], v[64:67], v[232:235], 0
    v_exp_f32 v23, v23
    v_mfma_f32_16x16x32_bf16 v[52:55], v[68:71], v[224:227], 0
    v_exp_f32 v24, v24
    v_mfma_f32_16x16x32_bf16 v[60:63], v[68:71], v[232:235], 0
    v_exp_f32 v25, v25
    v_mfma_f32_16x16x32_bf16 v[48:51], v[72:75], v[228:231], v[48:51]
    v_exp_f32 v26, v26
    v_mfma_f32_16x16x32_bf16 v[56:59], v[72:75], v[236:239], v[56:59]
    v_exp_f32 v27, v27
    v_mfma_f32_16x16x32_bf16 v[52:55], v[76:79], v[228:231], v[52:55]
    v_exp_f32 v28, v28
    v_mfma_f32_16x16x32_bf16 v[60:63], v[76:79], v[236:239], v[60:63]
    s_waitcnt vmcnt(4) lgkmcnt(0)
    v_exp_f32 v29, v29
    v_smfmac_f32_16x16x64_bf16 v[160:163], v[80:83], v[16:23], v10
    ds_read_b128 v[64:67], v2 offset:12288
    ds_read_b128 v[68:71], v2 offset:14336
    v_exp_f32 v30, v30
    v_smfmac_f32_16x16x64_bf16 v[168:171], v[84:87], v[16:23], v10
    ds_read_b128 v[72:75], v3 offset:12288
    ds_read_b128 v[76:79], v3 offset:14336
    v_exp_f32 v31, v31
    v_smfmac_f32_16x16x64_bf16 v[176:179], v[88:91], v[16:23], v10
    v_exp_f32 v48, v48
    v_smfmac_f32_16x16x64_bf16 v[184:187], v[92:95], v[16:23], v10
    v_exp_f32 v49, v49
    v_smfmac_f32_16x16x64_bf16 v[164:167], v[80:83], v[24:31], v10
    ds_read_b64_tr_b16 v[80:81], v6 offset:8192
    ds_read_b64_tr_b16 v[82:83], v6 offset:8704
    v_exp_f32 v50, v50
    v_smfmac_f32_16x16x64_bf16 v[172:175], v[84:87], v[24:31], v10
    ds_read_b64_tr_b16 v[84:85], v7 offset:8192
    ds_read_b64_tr_b16 v[86:87], v7 offset:8704
    v_exp_f32 v51, v51
    v_smfmac_f32_16x16x64_bf16 v[180:183], v[88:91], v[24:31], v10
    ds_read_b64_tr_b16 v[88:89], v8 offset:8192
    ds_read_b64_tr_b16 v[90:91], v8 offset:8704
    v_exp_f32 v52, v52
    v_smfmac_f32_16x16x64_bf16 v[188:191], v[92:95], v[24:31], v10
    ds_read_b64_tr_b16 v[92:93], v9 offset:8192
    ds_read_b64_tr_b16 v[94:95], v9 offset:8704
    s_waitcnt lgkmcnt(8)
    v_exp_f32 v53, v53
    v_mfma_f32_16x16x32_bf16 v[16:19], v[64:67], v[224:227], 0
    v_exp_f32 v54, v54
    v_mfma_f32_16x16x32_bf16 v[24:27], v[64:67], v[232:235], 0
    v_exp_f32 v55, v55
    v_mfma_f32_16x16x32_bf16 v[20:23], v[68:71], v[224:227], 0
    v_exp_f32 v56, v56
    v_mfma_f32_16x16x32_bf16 v[28:31], v[68:71], v[232:235], 0
    v_exp_f32 v57, v57
    v_mfma_f32_16x16x32_bf16 v[16:19], v[72:75], v[228:231], v[16:19]
    v_exp_f32 v58, v58
    v_mfma_f32_16x16x32_bf16 v[24:27], v[72:75], v[236:239], v[24:27]
    v_exp_f32 v59, v59
    v_mfma_f32_16x16x32_bf16 v[20:23], v[76:79], v[228:231], v[20:23]
    v_exp_f32 v60, v60
    v_mfma_f32_16x16x32_bf16 v[28:31], v[76:79], v[236:239], v[28:31]
    s_waitcnt vmcnt(12) lgkmcnt(0)
    v_exp_f32 v61, v61
    v_smfmac_f32_16x16x64_bf16 v[160:163], v[80:83], v[48:55], v10
    ds_read_b128 v[64:67], v2 offset:4096
    ds_read_b128 v[68:71], v2 offset:6144
    v_exp_f32 v62, v62
    v_smfmac_f32_16x16x64_bf16 v[168:171], v[84:87], v[48:55], v10
    ds_read_b128 v[72:75], v3 offset:4096
    ds_read_b128 v[76:79], v3 offset:6144
    v_exp_f32 v63, v63
    v_smfmac_f32_16x16x64_bf16 v[176:179], v[88:91], v[48:55], v10
    ds_read_b32 v241, v15 offset:20
    v_exp_f32 v16, v16
    v_smfmac_f32_16x16x64_bf16 v[184:187], v[92:95], v[48:55], v10
    v_exp_f32 v17, v17
    v_smfmac_f32_16x16x64_bf16 v[164:167], v[80:83], v[56:63], v10
    ds_read_b64_tr_b16 v[80:81], v6 offset:12288
    ds_read_b64_tr_b16 v[82:83], v6 offset:12800
    v_exp_f32 v18, v18
    v_smfmac_f32_16x16x64_bf16 v[172:175], v[84:87], v[56:63], v10
    ds_read_b64_tr_b16 v[84:85], v7 offset:12288
    ds_read_b64_tr_b16 v[86:87], v7 offset:12800
    v_exp_f32 v19, v19
    v_smfmac_f32_16x16x64_bf16 v[180:183], v[88:91], v[56:63], v10
    ds_read_b64_tr_b16 v[88:89], v8 offset:12288
    ds_read_b64_tr_b16 v[90:91], v8 offset:12800
    v_exp_f32 v20, v20
    v_smfmac_f32_16x16x64_bf16 v[188:191], v[92:95], v[56:63], v10
    ds_read_b64_tr_b16 v[92:93], v9 offset:12288
    ds_read_b64_tr_b16 v[94:95], v9 offset:12800
    s_waitcnt lgkmcnt(9)
    v_exp_f32 v21, v21
    v_mfma_f32_16x16x32_bf16 v[48:51], v[64:67], v[192:195], 0
    s_waitcnt lgkmcnt(8)
    v_readfirstlane_b32 s57, v241
    v_exp_f32 v22, v22
    v_mfma_f32_16x16x32_bf16 v[56:59], v[64:67], v[200:203], 0
    v_exp_f32 v23, v23
    v_mfma_f32_16x16x32_bf16 v[52:55], v[68:71], v[192:195], 0
    s_cmp_lt_u32 s57, 4
    s_cbranch_scc1 A_WC
A_WR:
    v_exp_f32 v24, v24
    v_mfma_f32_16x16x32_bf16 v[60:63], v[68:71], v[200:203], 0
    v_exp_f32 v25, v25
    v_mfma_f32_16x16x32_bf16 v[48:51], v[72:75], v[196:199], v[48:51]
    v_exp_f32 v26, v26
    v_mfma_f32_16x16x32_bf16 v[56:59], v[72:75], v[204:207], v[56:59]
    v_exp_f32 v27, v27
    v_mfma_f32_16x16x32_bf16 v[52:55], v[76:79], v[196:199], v[52:55]
    v_exp_f32 v28, v28
    v_mfma_f32_16x16x32_bf16 v[60:63], v[76:79], v[204:207], v[60:63]
    s_waitcnt vmcnt(8) lgkmcnt(0)
    v_exp_f32 v29, v29
    v_smfmac_f32_16x16x64_bf16 v[160:163], v[80:83], v[16:23], v10
    ds_read_b128 v[64:67], v2 offset:8192
    ds_read_b128 v[68:71], v2 offset:10240
    v_exp_f32 v30, v30
    v_smfmac_f32_16x16x64_bf16 v[168:171], v[84:87], v[16:23], v10
    ds_read_b128 v[72:75], v3 offset:8192
    ds_read_b128 v[76:79], v3 offset:10240
    v_exp_f32 v31, v31
    v_smfmac_f32_16x16x64_bf16 v[176:179], v[88:91], v[16:23], v10
    buffer_load_dwordx4 v[208:211], v13, s[20:23], 0 offen offset:0 sc1
    buffer_load_dwordx4 v[212:215], v13, s[20:23], 0 offen offset:128 sc1
    v_exp_f32 v48, v48
    v_smfmac_f32_16x16x64_bf16 v[184:187], v[92:95], v[16:23], v10
    buffer_load_dwordx4 v[216:219], v13, s[20:23], 0 offen offset:2048 sc1
    buffer_load_dwordx4 v[220:223], v13, s[20:23], 0 offen offset:2176 sc1
    v_exp_f32 v49, v49
    v_smfmac_f32_16x16x64_bf16 v[164:167], v[80:83], v[24:31], v10
    ds_read_b64_tr_b16 v[80:81], v6 offset:4096
    ds_read_b64_tr_b16 v[82:83], v6 offset:4608
    v_exp_f32 v50, v50
    v_smfmac_f32_16x16x64_bf16 v[172:175], v[84:87], v[24:31], v10
    ds_read_b64_tr_b16 v[84:85], v7 offset:4096
    ds_read_b64_tr_b16 v[86:87], v7 offset:4608
    v_exp_f32 v51, v51
    v_smfmac_f32_16x16x64_bf16 v[180:183], v[88:91], v[24:31], v10
    ds_read_b64_tr_b16 v[88:89], v8 offset:4096
    ds_read_b64_tr_b16 v[90:91], v8 offset:4608
    v_exp_f32 v52, v52
    v_smfmac_f32_16x16x64_bf16 v[188:191], v[92:95], v[24:31], v10
    ds_read_b64_tr_b16 v[92:93], v9 offset:4096
    ds_read_b64_tr_b16 v[94:95], v9 offset:4608
    s_waitcnt lgkmcnt(8)
    v_exp_f32 v53, v53
    v_mfma_f32_16x16x32_bf16 v[16:19], v[64:67], v[192:195], 0
    ds_write_b128 v14, v[160:163] offset:0
    v_exp_f32 v54, v54
    v_mfma_f32_16x16x32_bf16 v[24:27], v[64:67], v[200:203], 0
    ds_write_b128 v14, v[168:171] offset:2048
    v_exp_f32 v55, v55
    v_mfma_f32_16x16x32_bf16 v[20:23], v[68:71], v[192:195], 0
    ds_write_b128 v14, v[176:179] offset:4096
    v_exp_f32 v56, v56
    v_mfma_f32_16x16x32_bf16 v[28:31], v[68:71], v[200:203], 0
    ds_write_b128 v14, v[184:187] offset:6144
    v_exp_f32 v57, v57
    v_mfma_f32_16x16x32_bf16 v[16:19], v[72:75], v[196:199], v[16:19]
    ds_write_b128 v14, v[164:167] offset:256
    v_exp_f32 v58, v58
    v_mfma_f32_16x16x32_bf16 v[24:27], v[72:75], v[204:207], v[24:27]
    ds_write_b128 v14, v[172:175] offset:2304
    v_exp_f32 v59, v59
    v_mfma_f32_16x16x32_bf16 v[20:23], v[76:79], v[196:199], v[20:23]
    ds_write_b128 v14, v[180:183] offset:4352
    v_exp_f32 v60, v60
    v_mfma_f32_16x16x32_bf16 v[28:31], v[76:79], v[204:207], v[28:31]
    s_waitcnt vmcnt(8) lgkmcnt(7)
    ds_write_b128 v14, v[188:191] offset:6400
    s_mov_b64 exec, 1
    ds_add_u32 v15, v240 offset:8
    s_mov_b64 exec, -1
    v_exp_f32 v61, v61
    v_smfmac_f32_16x16x64_bf16 v[96:99], v[80:83], v[48:55], v10
    ds_read_b128 v[64:67], v2 offset:12288
    ds_read_b128 v[68:71], v2 offset:14336
    v_exp_f32 v62, v62
    v_smfmac_f32_16x16x64_bf16 v[104:107], v[84:87], v[48:55], v10
    ds_read_b128 v[72:75], v3 offset:12288
    ds_read_b128 v[76:79], v3 offset:14336
    v_exp_f32 v63, v63
    v_smfmac_f32_16x16x64_bf16 v[112:115], v[88:91], v[48:55], v10
    buffer_load_dwordx4 v[224:227], v13, s[20:23], s62 offen offset:0 sc1
    buffer_load_dwordx4 v[228:231], v13, s[20:23], s62 offen offset:128 sc1
    v_exp_f32 v16, v16
    v_smfmac_f32_16x16x64_bf16 v[120:123], v[92:95], v[48:55], v10
    buffer_load_dwordx4 v[232:235], v13, s[20:23], s62 offen offset:2048 sc1
    buffer_load_dwordx4 v[236:239], v13, s[20:23], s62 offen offset:2176 sc1
    v_exp_f32 v17, v17
    v_smfmac_f32_16x16x64_bf16 v[100:103], v[80:83], v[56:63], v10
    ds_read_b64_tr_b16 v[80:81], v6 offset:8192
    ds_read_b64_tr_b16 v[82:83], v6 offset:8704
    v_exp_f32 v18, v18
    v_smfmac_f32_16x16x64_bf16 v[108:111], v[84:87], v[56:63], v10
    ds_read_b64_tr_b16 v[84:85], v7 offset:8192
    ds_read_b64_tr_b16 v[86:87], v7 offset:8704
    v_exp_f32 v19, v19
    v_smfmac_f32_16x16x64_bf16 v[116:119], v[88:91], v[56:63], v10
    ds_read_b64_tr_b16 v[88:89], v8 offset:8192
    ds_read_b64_tr_b16 v[90:91], v8 offset:8704
    v_exp_f32 v20, v20
    v_smfmac_f32_16x16x64_bf16 v[124:127], v[92:95], v[56:63], v10
    ds_read_b64_tr_b16 v[92:93], v9 offset:8192
    ds_read_b64_tr_b16 v[94:95], v9 offset:8704
    s_waitcnt lgkmcnt(8)
    v_exp_f32 v21, v21
    v_mfma_f32_16x16x32_bf16 v[48:51], v[64:67], v[192:195], 0
    v_exp_f32 v22, v22
    v_mfma_f32_16x16x32_bf16 v[56:59], v[64:67], v[200:203], 0
    v_exp_f32 v23, v23
    v_mfma_f32_16x16x32_bf16 v[52:55], v[68:71], v[192:195], 0
    v_exp_f32 v24, v24
    v_mfma_f32_16x16x32_bf16 v[60:63], v[68:71], v[200:203], 0
    v_exp_f32 v25, v25
    v_mfma_f32_16x16x32_bf16 v[48:51], v[72:75], v[196:199], v[48:51]
    v_exp_f32 v26, v26
    v_mfma_f32_16x16x32_bf16 v[56:59], v[72:75], v[204:207], v[56:59]
    v_exp_f32 v27, v27
    v_mfma_f32_16x16x32_bf16 v[52:55], v[76:79], v[196:199], v[52:55]
    v_exp_f32 v28, v28
    v_mfma_f32_16x16x32_bf16 v[60:63], v[76:79], v[204:207], v[60:63]
    s_waitcnt vmcnt(8) lgkmcnt(0)
    v_exp_f32 v29, v29
    v_smfmac_f32_16x16x64_bf16 v[96:99], v[80:83], v[16:23], v10
    ds_read_b128 v[64:67], v2 offset:16384
    ds_read_b128 v[68:71], v2 offset:18432
    v_exp_f32 v30, v30
    v_smfmac_f32_16x16x64_bf16 v[104:107], v[84:87], v[16:23], v10
    ds_read_b128 v[72:75], v3 offset:16384
    ds_read_b128 v[76:79], v3 offset:18432
    v_exp_f32 v31, v31
    v_smfmac_f32_16x16x64_bf16 v[112:115], v[88:91], v[16:23], v10
    buffer_load_dwordx4 v[32:35], v12, s[16:19], 0 offen
    v_exp_f32 v48, v48
    v_smfmac_f32_16x16x64_bf16 v[120:123], v[92:95], v[16:23], v10
    v_exp_f32 v49, v49
    v_smfmac_f32_16x16x64_bf16 v[100:103], v[80:83], v[24:31], v10
    ds_read_b64_tr_b16 v[80:81], v6 offset:12288
    ds_read_b64_tr_b16 v[82:83], v6 offset:12800
    v_exp_f32 v50, v50
    v_smfmac_f32_16x16x64_bf16 v[108:111], v[84:87], v[24:31], v10
    ds_read_b64_tr_b16 v[84:85], v7 offset:12288
    ds_read_b64_tr_b16 v[86:87], v7 offset:12800
    v_exp_f32 v51, v51
    v_smfmac_f32_16x16x64_bf16 v[116:119], v[88:91], v[24:31], v10
    ds_read_b64_tr_b16 v[88:89], v8 offset:12288
    ds_read_b64_tr_b16 v[90:91], v8 offset:12800
    v_exp_f32 v52, v52
    v_smfmac_f32_16x16x64_bf16 v[124:127], v[92:95], v[24:31], v10
    ds_read_b64_tr_b16 v[92:93], v9 offset:12288
    ds_read_b64_tr_b16 v[94:95], v9 offset:12800
    s_waitcnt lgkmcnt(8)
    v_exp_f32 v53, v53
    v_mfma_f32_16x16x32_bf16 v[16:19], v[64:67], v[192:195], 0
    v_exp_f32 v54, v54
    v_mfma_f32_16x16x32_bf16 v[24:27], v[64:67], v[200:203], 0
    v_exp_f32 v55, v55
    v_mfma_f32_16x16x32_bf16 v[20:23], v[68:71], v[192:195], 0
    v_exp_f32 v56, v56
    v_mfma_f32_16x16x32_bf16 v[28:31], v[68:71], v[200:203], 0
    v_exp_f32 v57, v57
    v_mfma_f32_16x16x32_bf16 v[16:19], v[72:75], v[196:199], v[16:19]
    v_exp_f32 v58, v58
    v_mfma_f32_16x16x32_bf16 v[24:27], v[72:75], v[204:207], v[24:27]
    v_exp_f32 v59, v59
    v_mfma_f32_16x16x32_bf16 v[20:23], v[76:79], v[196:199], v[20:23]
    v_exp_f32 v60, v60
    v_mfma_f32_16x16x32_bf16 v[28:31], v[76:79], v[204:207], v[28:31]
    s_waitcnt lgkmcnt(0)
    v_exp_f32 v61, v61
    v_smfmac_f32_16x16x64_bf16 v[96:99], v[80:83], v[48:55], v10
    v_exp_f32 v62, v62
    v_smfmac_f32_16x16x64_bf16 v[104:107], v[84:87], v[48:55], v10
    v_exp_f32 v63, v63
    v_smfmac_f32_16x16x64_bf16 v[112:115], v[88:91], v[48:55], v10
    v_exp_f32 v16, v16
    v_smfmac_f32_16x16x64_bf16 v[120:123], v[92:95], v[48:55], v10
    v_exp_f32 v17, v17
    v_smfmac_f32_16x16x64_bf16 v[100:103], v[80:83], v[56:63], v10
    ds_read_b64_tr_b16 v[80:81], v6 offset:16384
    ds_read_b64_tr_b16 v[82:83], v6 offset:16896
    v_exp_f32 v18, v18
    v_smfmac_f32_16x16x64_bf16 v[108:111], v[84:87], v[56:63], v10
    ds_read_b64_tr_b16 v[84:85], v7 offset:16384
    ds_read_b64_tr_b16 v[86:87], v7 offset:16896
    v_exp_f32 v19, v19
    v_smfmac_f32_16x16x64_bf16 v[116:119], v[88:91], v[56:63], v10
    ds_read_b64_tr_b16 v[88:89], v8 offset:16384
    ds_read_b64_tr_b16 v[90:91], v8 offset:16896
    v_exp_f32 v20, v20
    v_smfmac_f32_16x16x64_bf16 v[124:127], v[92:95], v[56:63], v10
    ds_read_b64_tr_b16 v[92:93], v9 offset:16384
    ds_read_b64_tr_b16 v[94:95], v9 offset:16896
    v_exp_f32 v21, v21
    v_exp_f32 v22, v22
    v_exp_f32 v23, v23
    v_exp_f32 v24, v24
    v_exp_f32 v25, v25
    v_exp_f32 v26, v26
    v_exp_f32 v27, v27
    v_exp_f32 v28, v28
    s_waitcnt lgkmcnt(0)
    v_exp_f32 v29, v29
    v_smfmac_f32_16x16x64_bf16 v[96:99], v[80:83], v[16:23], v10
    v_exp_f32 v30, v30
    v_smfmac_f32_16x16x64_bf16 v[104:107], v[84:87], v[16:23], v10
    v_exp_f32 v31, v31
    s_waitcnt lgkmcnt(0)
    v_smfmac_f32_16x16x64_bf16 v[112:115], v[88:91], v[16:23], v10
    v_smfmac_f32_16x16x64_bf16 v[120:123], v[92:95], v[16:23], v10
    v_smfmac_f32_16x16x64_bf16 v[100:103], v[80:83], v[24:31], v10
    v_smfmac_f32_16x16x64_bf16 v[108:111], v[84:87], v[24:31], v10
    v_smfmac_f32_16x16x64_bf16 v[116:119], v[88:91], v[24:31], v10
    v_smfmac_f32_16x16x64_bf16 v[124:127], v[92:95], v[24:31], v10
    v_add_u32 v14, s36, v4
    s_nop 1
    ds_write_b128 v14, v[96:99] offset:0
    ds_write_b128 v14, v[104:107] offset:2048
    ds_write_b128 v14, v[112:115] offset:4096
    ds_write_b128 v14, v[120:123] offset:6144
    ds_write_b128 v14, v[100:103] offset:256
    ds_write_b128 v14, v[108:111] offset:2304
    ds_write_b128 v14, v[116:119] offset:4352
    s_nop 0
    ds_write_b128 v14, v[124:127] offset:6400
    s_mov_b64 exec, 1
    ds_add_u32 v15, v240 offset:12
    s_mov_b64 exec, -1
    s_branch FINAL
A_WC:
    s_mov_b32 s58, 800000
A_WC1:
    ds_read_b32 v241, v15 offset:20
    s_waitcnt lgkmcnt(0)
    v_readfirstlane_b32 s57, v241
    s_sub_u32 s58, s58, 1
    s_cbranch_scc1 A_WC1_X
    s_cmp_lt_u32 s57, 4
    s_cbranch_scc1 A_WC1
A_WC1_X:
    s_branch A_WR
A_KE:
    s_mov_b32 exec_lo, 0
    s_mov_b32 exec_hi, 0xffff0000
    v_mov_b32 v215, 0xff7f0000
    v_mov_b32 v223, 0xff7f0000
    s_mov_b64 exec, -1
    s_branch A_KR
A_WP:
    s_mov_b32 s58, 800000
A_WP1:
    ds_read_b32 v241, v15 offset:36
    s_waitcnt lgkmcnt(0)
    v_readfirstlane_b32 s57, v241
    s_sub_u32 s58, s58, 1
    s_cbranch_scc1 A_WP1_X
    s_cmp_lt_u32 s57, 4
    s_cbranch_scc1 A_WP1
A_WP1_X:
    s_branch A_WPR
A3:
    s_load_dwordx4 s[28:31], s[0:1], 40
    v_and_b32 v3, 31, v0
    v_lshrrev_b32 v4, 5, v0
    v_and_b32 v6, 0x13, v3
    v_and_b32 v7, 4, v3
    v_lshl_or_b32 v6, v7, 1, v6
    v_and_b32 v7, 8, v3
    v_lshrrev_b32 v7, 1, v7
    v_or_b32 v6, v6, v7
    v_lshlrev_b32 v6, 7, v6
    v_lshl_add_u32 v6, v4, 4, v6
    v_add_u32 v244, 150464, v11
    s_waitcnt lgkmcnt(0)
    s_mov_b64 s[64:65], s[28:29]
    v_mov_b32 v245, v6
    s_add_u32 s12, s4, 0x290000
    s_addc_u32 s13, s5, 0
    s_mov_b32 s14, 0x14000
    s_mov_b32 s15, 0x20000
    v_mov_b32 v240, 1
    s_load_dwordx2 s[6:7], s[0:1], 0
    s_load_dwordx2 s[28:29], s[0:1], 72
    s_mul_i32 s42, s39, 323584
    s_sub_u32 s10, 1280000, s42
    s_min_u32 s10, s10, 323584
    s_mov_b32 s11, 0x20000
    s_add_u32 s8, s4, s42
    s_addc_u32 s9, s5, 0
    s_mul_i32 s36, s39, 20480
    s_add_u32 s48, s36, 0
    s_add_u32 s49, s36, 4096
    s_add_u32 s50, s36, 8192
    s_add_u32 s51, s36, 12288
    s_add_u32 s52, s36, 16384
    s_lshl_b32 s45, s41, 13
    s_sub_u32 s45, 0x1000, s45
    s_mul_i32 s37, s41, 319488
    s_lshl_b32 s42, s41, 12
    s_sub_u32 s42, 159744, s42
    s_mul_i32 s47, s45, -80
    s_cmp_eq_u32 s46, 0
    s_cselect_b32 s37, s37, s42
    s_cselect_b32 s47, 0, s47
    s_cmp_eq_u32 s34, 3
    s_cselect_b32 s47, 319488, s45
    s_cselect_b32 s53, 0, -1
    v_lshrrev_b32 v18, 4, v0
    v_and_b32 v19, 15, v0
    v_lshlrev_b32 v4, 4, v19
    v_lshl_add_u32 v4, v18, 9, v4
    v_lshlrev_b32 v2, 7, v19
    v_lshl_add_u32 v2, v18, 4, v2
    v_and_b32 v19, 2, v0
    v_lshlrev_b32 v19, 5, v19
    v_xor_b32 v2, v2, v19
    v_and_b32 v19, 8, v0
    v_lshlrev_b32 v3, 2, v19
    v_xor_b32 v2, v2, v3
    v_add_u32 v2, s36, v2
    v_xor_b32 v3, 64, v2
    v_lshlrev_b32 v6, 3, v19
    v_lshl_add_u32 v6, v18, 10, v6
    v_and_b32 v18, 1, v18
    v_lshl_add_u32 v6, v18, 5, v6
    v_bfe_u32 v18, v0, 2, 2
    v_lshl_add_u32 v6, v18, 7, v6
    v_and_b32 v18, 3, v0
    v_lshl_add_u32 v6, v18, 3, v6
    v_add_u32 v6, s36, v6
    v_xor_b32 v7, 32, v6
    v_xor_b32 v8, 64, v6
    v_xor_b32 v9, 96, v6
    v_mov_b32 v10, 0xdddddddd
    v_and_b32 v18, 16, v0
    v_lshlrev_b32 v18, 2, v18
    v_xor_b32 v242, v18, v11
    v_xor_b32 v243, 32, v242
    s_waitcnt lgkmcnt(0)
    v_and_b32 v16, 15, v0
    v_and_b32 v17, 48, v0
    s_lshr_b32 s42, s39, 1
    v_lshl_add_u32 v19, s42, 4, v16
    s_cmp_ge_u32 s3, 4
    s_cselect_b32 s54, 0, 256
    s_lshl_b32 s55, s54, 4
    s_add_u32 s54, s54, 137024
    s_add_u32 s55, s55, 150464
    v_lshl_add_u32 v249, v19, 2, s54
    v_lshl_add_u32 v250, v19, 4, s55
    v_lshl_add_u32 v250, v17, 5, v250
    v_or_b32 v251, 32, v0
    v_lshl_add_u32 v251, v251, 2, v15
    v_and_b32 v18, 7, v16
    v_and_b32 v13, 8, v16
    v_lshl_add_u32 v13, v13, 1, v18
    v_lshl_add_u32 v13, v17, 1, v13
    v_lshlrev_b32 v13, 4, v13
    v_add_u32 v18, 32, v18
    s_cmp_ge_u32 s3, 4
    s_cselect_b64 vcc, -1, 0
    v_cndmask_b32 v16, v19, v18, vcc
    v_lshrrev_b32 v19, 3, v19
    v_cmp_eq_u32 s[54:55], s34, v19
    v_mul_u32_u24 v1, 144, v16
    v_add_u32 v1, v1, v17
    v_add_u32 v1, 131072, v1
    v_lshl_add_u32 v12, v16, 7, v17
    s_andn2_b64 vcc, vcc, s[54:55]
    s_and_b32 s54, s39, 1
    s_mul_i32 s42, s33, 80
    s_add_u32 s42, s42, s54
    s_lshl_b32 s42, s42, 6
    v_add_u32 v12, s42, v12
    v_mov_b32 v18, 0x70000000
    v_cndmask_b32 v12, v12, v18, vcc
    s_lshl_b32 s42, s54, 12
    v_add_u32 v13, s42, v13
    s_lshl_b32 s42, s39, 13
    s_add_u32 s42, s42, 81920
    v_add_u32 v14, s42, v11
    v_add_u32 v14, s42, v4
    s_lshl_b32 s54, s34, 3
    s_lshl_b32 s54, 0xff, s54
    s_mov_b32 s55, s54
    s_mov_b32 s16, s6
    s_mov_b32 s17, s7
    s_mov_b32 s18, 0x138800
    s_mov_b32 s19, 0x20000
    s_add_u32 s20, s4, 0x280000
    s_addc_u32 s21, s5, 0
    s_mov_b32 s22, 0x4000
    s_mov_b32 s23, 0x20000
    s_mov_b32 s24, s28
    s_mov_b32 s25, s29
    s_mov_b32 s26, 0x138800
    s_mov_b32 s27, 0x20000
    s_movk_i32 s61, 0x1000
    s_movk_i32 s62, 0x2000
    s_movk_i32 s63, 0x3000
    v_mov_b64 v[96:97], 0
    v_mov_b64 v[98:99], 0
    v_mov_b64 v[100:101], 0
    v_mov_b64 v[102:103], 0
    v_mov_b64 v[104:105], 0
    v_mov_b64 v[106:107], 0
    v_mov_b64 v[108:109], 0
    v_mov_b64 v[110:111], 0
    v_mov_b64 v[112:113], 0
    v_mov_b64 v[114:115], 0
    v_mov_b64 v[116:117], 0
    v_mov_b64 v[118:119], 0
    v_mov_b64 v[120:121], 0
    v_mov_b64 v[122:123], 0
    v_mov_b64 v[124:125], 0
    v_mov_b64 v[126:127], 0
    s_movk_i32 s66, 0x2000
    s_mov_b32 s67, 0x20000
    s_mov_b32 s56, s30
    s_mov_b32 s57, s31
    s_mov_b32 s58, 0x2000
    s_mov_b32 s59, 0x20000
    s_movk_i32 s43, 0x1000
    s_barrier
    v_lshrrev_b32 v16, 3, v0
    v_lshlrev_b32 v16, 4, v16
    v_xor_b32 v16, v16, v11
    s_mov_b32 m0, s48
    s_nop 0
    buffer_load_dwordx4 v16, s[64:67], 0 offen offset:0 lds
    buffer_load_dwordx4 v16, s[64:67], 0 offen offset:1024 lds
    buffer_load_dwordx4 v16, s[64:67], 0 offen offset:2048 lds
    buffer_load_dwordx4 v16, s[64:67], 0 offen offset:3072 lds
    s_mov_b32 m0, s49
    s_nop 0
    buffer_load_dwordx4 v16, s[64:67], s43 offen offset:0 lds
    buffer_load_dwordx4 v16, s[64:67], s43 offen offset:1024 lds
    buffer_load_dwordx4 v16, s[64:67], s43 offen offset:2048 lds
    buffer_load_dwordx4 v16, s[64:67], s43 offen offset:3072 lds
    s_mov_b32 m0, s50
    s_nop 0
    buffer_load_dwordx4 v16, s[56:59], 0 offen offset:0 lds
    buffer_load_dwordx4 v16, s[56:59], 0 offen offset:1024 lds
    buffer_load_dwordx4 v16, s[56:59], 0 offen offset:2048 lds
    buffer_load_dwordx4 v16, s[56:59], 0 offen offset:3072 lds
    s_mov_b32 m0, s51
    s_nop 0
    buffer_load_dwordx4 v16, s[56:59], s43 offen offset:0 lds
    buffer_load_dwordx4 v16, s[56:59], s43 offen offset:1024 lds
    buffer_load_dwordx4 v16, s[56:59], s43 offen offset:2048 lds
    buffer_load_dwordx4 v16, s[56:59], s43 offen offset:3072 lds
    v_bfe_u32 v16, v245, 7, 3
    v_lshlrev_b32 v16, 4, v16
    v_xor_b32 v16, v16, v245
    v_add_u32 v16, s36, v16
    v_xor_b32 v17, 32, v16
    v_xor_b32 v18, 64, v16
    v_xor_b32 v19, 96, v16
    s_waitcnt vmcnt(0)
    ds_read_b128 v[32:35], v16 offset:0
    ds_read_b128 v[48:51], v16 offset:4096
    ds_read_b128 v[64:67], v16 offset:8192
    ds_read_b128 v[80:83], v16 offset:12288
    ds_read_b128 v[36:39], v17 offset:0
    ds_read_b128 v[52:55], v17 offset:4096
    ds_read_b128 v[68:71], v17 offset:8192
    ds_read_b128 v[84:87], v17 offset:12288
    ds_read_b128 v[40:43], v18 offset:0
    ds_read_b128 v[56:59], v18 offset:4096
    ds_read_b128 v[72:75], v18 offset:8192
    ds_read_b128 v[88:91], v18 offset:12288
    ds_read_b128 v[44:47], v19 offset:0
    ds_read_b128 v[60:63], v19 offset:4096
    ds_read_b128 v[76:79], v19 offset:8192
    ds_read_b128 v[92:95], v19 offset:12288
    s_waitcnt lgkmcnt(0)
    v_mfma_f32_32x32x16_bf16 v[128:143], v[32:35], v[64:67], 0
    v_mfma_f32_32x32x16_bf16 v[160:175], v[32:35], v[80:83], 0
    v_mfma_f32_32x32x16_bf16 v[144:159], v[48:51], v[64:67], 0
    v_mfma_f32_32x32x16_bf16 v[176:191], v[48:51], v[80:83], 0
    v_mfma_f32_32x32x16_bf16 v[128:143], v[36:39], v[68:71], v[128:143]
    v_mfma_f32_32x32x16_bf16 v[160:175], v[36:39], v[84:87], v[160:175]
    v_mfma_f32_32x32x16_bf16 v[144:159], v[52:55], v[68:71], v[144:159]
    v_mfma_f32_32x32x16_bf16 v[176:191], v[52:55], v[84:87], v[176:191]
    v_mfma_f32_32x32x16_bf16 v[128:143], v[40:43], v[72:75], v[128:143]
    v_mfma_f32_32x32x16_bf16 v[160:175], v[40:43], v[88:91], v[160:175]
    v_mfma_f32_32x32x16_bf16 v[144:159], v[56:59], v[72:75], v[144:159]
    v_mfma_f32_32x32x16_bf16 v[176:191], v[56:59], v[88:91], v[176:191]
    v_mfma_f32_32x32x16_bf16 v[128:143], v[44:47], v[76:79], v[128:143]
    v_mfma_f32_32x32x16_bf16 v[160:175], v[44:47], v[92:95], v[160:175]
    v_mfma_f32_32x32x16_bf16 v[144:159], v[60:63], v[76:79], v[144:159]
    v_mfma_f32_32x32x16_bf16 v[176:191], v[60:63], v[92:95], v[176:191]
    s_nop 7
    s_nop 3
    v_cvt_pk_bf16_f32 v192, v128, v129
    v_cvt_pk_bf16_f32 v193, v130, v131
    v_cvt_pk_bf16_f32 v194, v132, v133
    v_cvt_pk_bf16_f32 v195, v134, v135
    ds_write_b128 v244, v[192:195] offset:0
    v_cvt_pk_bf16_f32 v196, v136, v137
    v_cvt_pk_bf16_f32 v197, v138, v139
    v_cvt_pk_bf16_f32 v198, v140, v141
    v_cvt_pk_bf16_f32 v199, v142, v143
    ds_write_b128 v244, v[196:199] offset:1024
    v_cvt_pk_bf16_f32 v208, v160, v161
    v_cvt_pk_bf16_f32 v209, v162, v163
    v_cvt_pk_bf16_f32 v210, v164, v165
    v_cvt_pk_bf16_f32 v211, v166, v167
    ds_write_b128 v244, v[208:211] offset:4096
    v_cvt_pk_bf16_f32 v212, v168, v169
    v_cvt_pk_bf16_f32 v213, v170, v171
    v_cvt_pk_bf16_f32 v214, v172, v173
    v_cvt_pk_bf16_f32 v215, v174, v175
    ds_write_b128 v244, v[212:215] offset:5120
    v_cvt_pk_bf16_f32 v200, v144, v145
    v_cvt_pk_bf16_f32 v201, v146, v147
    v_cvt_pk_bf16_f32 v202, v148, v149
    v_cvt_pk_bf16_f32 v203, v150, v151
    ds_write_b128 v244, v[200:203] offset:2048
    v_cvt_pk_bf16_f32 v204, v152, v153
    v_cvt_pk_bf16_f32 v205, v154, v155
    v_cvt_pk_bf16_f32 v206, v156, v157
    v_cvt_pk_bf16_f32 v207, v158, v159
    ds_write_b128 v244, v[204:207] offset:3072
    v_cvt_pk_bf16_f32 v216, v176, v177
    v_cvt_pk_bf16_f32 v217, v178, v179
    v_cvt_pk_bf16_f32 v218, v180, v181
    v_cvt_pk_bf16_f32 v219, v182, v183
    ds_write_b128 v244, v[216:219] offset:6144
    v_cvt_pk_bf16_f32 v220, v184, v185
    v_cvt_pk_bf16_f32 v221, v186, v187
    v_cvt_pk_bf16_f32 v222, v188, v189
    v_cvt_pk_bf16_f32 v223, v190, v191
    ds_write_b128 v244, v[220:223] offset:7168
    s_mov_b64 exec, 1
    ds_add_u32 v15, v240 offset:44
    s_mov_b64 exec, -1
    v_mov_b64 v[128:129], 0
    v_mov_b64 v[130:131], 0
    v_mov_b64 v[132:133], 0
    v_mov_b64 v[134:135], 0
    v_mov_b64 v[136:137], 0
    v_mov_b64 v[138:139], 0
    v_mov_b64 v[140:141], 0
    v_mov_b64 v[142:143], 0
    v_mov_b64 v[144:145], 0
    v_mov_b64 v[146:147], 0
    v_mov_b64 v[148:149], 0
    v_mov_b64 v[150:151], 0
    v_mov_b64 v[152:153], 0
    v_mov_b64 v[154:155], 0
    v_mov_b64 v[156:157], 0
    v_mov_b64 v[158:159], 0
    v_mov_b64 v[160:161], 0
    v_mov_b64 v[162:163], 0
    v_mov_b64 v[164:165], 0
    v_mov_b64 v[166:167], 0
    v_mov_b64 v[168:169], 0
    v_mov_b64 v[170:171], 0
    v_mov_b64 v[172:173], 0
    v_mov_b64 v[174:175], 0
    v_mov_b64 v[176:177], 0
    v_mov_b64 v[178:179], 0
    v_mov_b64 v[180:181], 0
    v_mov_b64 v[182:183], 0
    v_mov_b64 v[184:185], 0
    v_mov_b64 v[186:187], 0
    v_mov_b64 v[188:189], 0
    v_mov_b64 v[190:191], 0
    s_branch A_MAIN
B_MAIN:
    s_load_dwordx4 s[28:31], s[0:1], 8
    s_load_dwordx2 s[16:17], s[0:1], 0
    s_load_dwordx2 s[8:9], s[0:1], 80
    s_mul_i32 s42, s33, 5120
    s_lshl_b32 s43, s39, 8
    s_lshl2_add_u32 s44, s43, s42
    s_add_u32 s43, s43, s42
    s_add_u32 s43, s43, 0x1000
    v_add_u32 v212, s44, v11
    v_add_u32 v152, s43, v11
    s_mov_b32 s18, 1280000
    s_mov_b32 s19, 0x20000
    s_waitcnt lgkmcnt(0)
    buffer_load_dwordx4 v[200:203], v212, s[16:19], 0 offen
    s_mov_b64 exec, 0xffff
    buffer_load_dwordx4 v[140:143], v152, s[16:19], 0 offen
    s_mov_b64 exec, -1
    s_lshl_b32 s42, s39, 6
    v_add_u32 v2, s42, v0
    v_lshlrev_b32 v3, 4, v2
    v_lshlrev_b32 v4, 3, v2
    s_mul_i32 s50, s33, 10240
    s_add_u32 s43, s50, 0x1000
    s_add_u32 s44, s50, 0x2000
    s_waitcnt lgkmcnt(0)
    s_mov_b32 s20, s30
    s_mov_b32 s21, s31
    s_mov_b32 s22, 0x271000
    s_mov_b32 s23, 0x20000
    s_mov_b32 s24, s28
    s_mov_b32 s25, s29
    s_mov_b32 s26, 0x271000
    s_mov_b32 s27, 0x20000
    s_mov_b32 s49, 81920
    v_mov_b32 v10, 144
    v_lshrrev_b32 v5, 2, v2
    v_and_b32 v7, 3, v2
    v_mad_u32_u24 v73, v5, v10, s49
    v_lshl_add_u32 v73, v7, 4, v73
    s_and_b32 s42, s33, 15
    s_lshl_b32 s42, s42, 20
    s_add_u32 s42, s42, 0x1000000
    v_lshl_add_u32 v65, v7, 18, s42
    v_cmp_eq_u32 vcc, 0, v7
    v_mov_b32 v66, v65
    v_mov_b32 v67, v65
    v_mov_b32 v68, v65
    v_mov_b32 v69, v65
    v_addc_co_u32 v64, vcc, 0, v65, vcc
    ds_write_b128 v73, v[64:67] offset:0
    ds_write_b128 v73, v[66:69] offset:64
    ds_write_b128 v73, v[64:67] offset:9216
    ds_write_b128 v73, v[66:69] offset:9280
    ds_write_b128 v73, v[64:67] offset:18432
    ds_write_b128 v73, v[66:69] offset:18496
    ds_write_b128 v73, v[64:67] offset:27648
    ds_write_b128 v73, v[66:69] offset:27712
    v_mov_b32 v80, -1
    v_mov_b32 v84, 0
    v_mov_b32 v81, -1
    v_mov_b32 v85, 0
    v_mov_b32 v82, -1
    v_mov_b32 v86, 0
    v_mov_b32 v83, -1
    v_mov_b32 v87, 0
    v_add_u32 v5, 138176, v3
    ds_write_b128 v5, v[80:83] offset:0
    ds_write_b128 v5, v[80:83] offset:4096
    ds_write_b128 v5, v[80:83] offset:8192
    v_mov_b32 v6, 1
    v_lshlrev_b32 v5, 2, v0
    v_add_u32 v8, 137664, v5
    v_add_u32 v5, 137152, v5
    v_lshlrev_b32 v9, 8, v0
    v_add_u32 v9, 138176, v9
    ds_write2st64_b32 v8, v9, v5 offset0:0 offset1:1
    ds_write_b128 v15, v[84:87] offset:0
    ds_write_b128 v15, v[84:87] offset:16
    ds_write_b128 v15, v[84:87] offset:32
    s_add_u32 s28, s4, 0xb00000
    s_addc_u32 s29, s5, 0
    s_mov_b32 s30, 0x800000
    s_mov_b32 s31, 0x20000
    s_add_u32 s12, s4, 0x290000
    s_addc_u32 s13, s5, 0
    s_mov_b32 s14, 0x14000
    s_mov_b32 s15, 0x20000
    s_mov_b32 s47, 52429
    v_mov_b32 v7, 31
    s_mov_b32 s52, s4
    s_mov_b32 s53, s5
    s_mov_b32 s54, 0x138800
    s_mov_b32 s55, 0x20000
    s_movk_i32 s10, 256
    s_mov_b32 s11, 0x20000
    s_mov_b32 vcc_lo, 0x80808080
    s_mov_b32 vcc_hi, vcc_lo
    s_waitcnt lgkmcnt(0)
    s_barrier
    s_waitcnt vmcnt(0)
    buffer_load_dword v5, off, s[8:11], 0 sc1
    v_lshlrev_b32 v204, 16, v200
    v_lshlrev_b32 v144, 16, v140
    v_and_b32 v205, 0xffff0000, v200
    v_and_b32 v145, 0xffff0000, v140
    v_lshlrev_b32 v206, 16, v201
    v_lshlrev_b32 v146, 16, v141
    v_and_b32 v207, 0xffff0000, v201
    v_and_b32 v147, 0xffff0000, v141
    v_lshlrev_b32 v208, 16, v202
    v_lshlrev_b32 v148, 16, v142
    v_and_b32 v209, 0xffff0000, v202
    v_and_b32 v149, 0xffff0000, v142
    v_lshlrev_b32 v210, 16, v203
    v_lshlrev_b32 v150, 16, v143
    v_and_b32 v211, 0xffff0000, v203
    v_and_b32 v151, 0xffff0000, v143
    v_pk_add_f32 v[214:215], v[204:205], v[206:207]
    v_pk_add_f32 v[154:155], v[144:145], v[146:147]
    v_pk_add_f32 v[216:217], v[208:209], v[210:211]
    v_pk_add_f32 v[156:157], v[148:149], v[150:151]
    v_pk_add_f32 v[214:215], v[214:215], v[216:217]
    v_pk_add_f32 v[154:155], v[154:155], v[156:157]
    v_add_f32 v214, v214, v215
    v_add_f32 v154, v154, v155
    s_nop 0
    v_add_f32_dpp v214, v214, v214 quad_perm:[1,0,3,2] row_mask:0xf bank_mask:0xf
    v_add_f32_dpp v154, v154, v154 quad_perm:[1,0,3,2] row_mask:0xf bank_mask:0xf
    s_nop 0
    v_add_f32_dpp v214, v214, v214 quad_perm:[2,3,0,1] row_mask:0xf bank_mask:0xf
    v_add_f32_dpp v154, v154, v154 quad_perm:[2,3,0,1] row_mask:0xf bank_mask:0xf
    s_nop 0
    v_add_f32_dpp v214, v214, v214 row_half_mirror row_mask:0xf bank_mask:0xf
    v_add_f32_dpp v154, v154, v154 row_half_mirror row_mask:0xf bank_mask:0xf
    v_mul_f32 v214, 0xbc800000, v214
    v_mul_f32 v154, 0xbc800000, v154
    v_pk_add_f32 v[204:205], v[204:205], v[214:215] op_sel_hi:[1,0]
    v_pk_add_f32 v[144:145], v[144:145], v[154:155] op_sel_hi:[1,0]
    v_pk_add_f32 v[206:207], v[206:207], v[214:215] op_sel_hi:[1,0]
    v_pk_add_f32 v[146:147], v[146:147], v[154:155] op_sel_hi:[1,0]
    v_pk_add_f32 v[208:209], v[208:209], v[214:215] op_sel_hi:[1,0]
    v_pk_add_f32 v[148:149], v[148:149], v[154:155] op_sel_hi:[1,0]
    v_pk_add_f32 v[210:211], v[210:211], v[214:215] op_sel_hi:[1,0]
    v_pk_add_f32 v[150:151], v[150:151], v[154:155] op_sel_hi:[1,0]
    v_pk_mul_f32 v[214:215], v[204:205], v[204:205]
    v_pk_mul_f32 v[154:155], v[144:145], v[144:145]
    v_pk_mul_f32 v[216:217], v[206:207], v[206:207]
    v_pk_mul_f32 v[156:157], v[146:147], v[146:147]
    v_pk_fma_f32 v[214:215], v[208:209], v[208:209], v[214:215]
    v_pk_fma_f32 v[154:155], v[148:149], v[148:149], v[154:155]
    v_pk_fma_f32 v[216:217], v[210:211], v[210:211], v[216:217]
    v_pk_fma_f32 v[156:157], v[150:151], v[150:151], v[156:157]
    v_pk_add_f32 v[214:215], v[214:215], v[216:217]
    v_pk_add_f32 v[154:155], v[154:155], v[156:157]
    v_add_f32 v214, v214, v215
    v_add_f32 v154, v154, v155
    s_nop 0
    v_add_f32_dpp v214, v214, v214 quad_perm:[1,0,3,2] row_mask:0xf bank_mask:0xf
    v_add_f32_dpp v154, v154, v154 quad_perm:[1,0,3,2] row_mask:0xf bank_mask:0xf
    s_nop 0
    v_add_f32_dpp v214, v214, v214 quad_perm:[2,3,0,1] row_mask:0xf bank_mask:0xf
    v_add_f32_dpp v154, v154, v154 quad_perm:[2,3,0,1] row_mask:0xf bank_mask:0xf
    s_nop 0
    v_add_f32_dpp v214, v214, v214 row_half_mirror row_mask:0xf bank_mask:0xf
    v_add_f32_dpp v154, v154, v154 row_half_mirror row_mask:0xf bank_mask:0xf
    v_mul_f32 v214, 0x3c800000, v214
    v_mul_f32 v154, 0x3c800000, v154
    v_cvt_pk_bf16_f32 v214, v214, v214
    v_cvt_pk_bf16_f32 v154, v154, v154
    v_lshlrev_b32 v214, 16, v214
    v_lshlrev_b32 v154, 16, v154
    v_add_f32 v214, 0x3727c5ac, v214
    v_add_f32 v154, 0x3727c5ac, v154
    v_cvt_pk_bf16_f32 v214, v214, v214
    v_cvt_pk_bf16_f32 v154, v154, v154
    v_lshlrev_b32 v214, 16, v214
    v_lshlrev_b32 v154, 16, v154
    v_sqrt_f32 v214, v214
    v_sqrt_f32 v154, v154
    s_nop 0
    v_cvt_pk_bf16_f32 v214, v214, v214
    v_cvt_pk_bf16_f32 v154, v154, v154
    v_lshlrev_b32 v214, 16, v214
    v_lshlrev_b32 v154, 16, v154
    v_rcp_f32 v214, v214
    v_rcp_f32 v154, v154
    s_nop 0
    v_pk_mul_f32 v[204:205], v[204:205], v[214:215] op_sel_hi:[1,0]
    v_pk_mul_f32 v[144:145], v[144:145], v[154:155] op_sel_hi:[1,0]
    v_pk_mul_f32 v[206:207], v[206:207], v[214:215] op_sel_hi:[1,0]
    v_pk_mul_f32 v[146:147], v[146:147], v[154:155] op_sel_hi:[1,0]
    v_pk_mul_f32 v[208:209], v[208:209], v[214:215] op_sel_hi:[1,0]
    v_pk_mul_f32 v[148:149], v[148:149], v[154:155] op_sel_hi:[1,0]
    v_pk_mul_f32 v[210:211], v[210:211], v[214:215] op_sel_hi:[1,0]
    v_pk_mul_f32 v[150:151], v[150:151], v[154:155] op_sel_hi:[1,0]
    v_cndmask_b32 v211, v211, 1.0, vcc
    v_cndmask_b32 v151, v151, 1.0, vcc
    v_cvt_pk_bf16_f32 v200, v204, v205
    v_cvt_pk_bf16_f32 v140, v144, v145
    v_cvt_pk_bf16_f32 v201, v206, v207
    v_cvt_pk_bf16_f32 v141, v146, v147
    v_cvt_pk_bf16_f32 v202, v208, v209
    v_cvt_pk_bf16_f32 v142, v148, v149
    v_cvt_pk_bf16_f32 v203, v210, v211
    v_cvt_pk_bf16_f32 v143, v150, v151
    buffer_store_dwordx4 v[200:203], v212, s[52:55], 0 offen sc1
    s_mov_b64 exec, 0xffff
    buffer_store_dwordx4 v[140:143], v152, s[52:55], 0 offen sc1
    s_mov_b64 exec, -1
    s_mov_b32 s58, 100000
    s_waitcnt vmcnt(0)
N_L:
    v_readfirstlane_b32 s35, v5
    s_sub_u32 s58, s58, 1
    s_cbranch_scc1 N_X
    s_cmp_lg_u32 s35, 0
    s_cbranch_scc1 N_X
    buffer_load_dword v5, off, s[8:11], 0 sc1
    s_waitcnt vmcnt(0)
    s_branch N_L
N_X:
    s_mov_b64 exec, 1
    ds_add_rtn_u32 v72, v15, v6 offset:28
    s_or_b32 s35, s35, 1
    s_lshl_b32 s42, s33, 7
    v_mov_b32 v5, s35
    s_waitcnt lgkmcnt(0)
    v_cmpx_eq_u32 vcc, 3, v72
    s_cbranch_execz N_G
    buffer_store_dword v5, off, s[12:15], s42 sc1
    ds_write_b32 v15, v5
N_G:
    s_mov_b64 exec, -1
    buffer_load_dwordx4 v[76:79], v3, s[20:23], s50 offen
    buffer_load_dwordx4 v[80:83], v3, s[20:23], s43 offen
    buffer_load_dwordx2 v[84:85], v4, s[20:23], s44 offen
    s_lshl_b32 s42, s39, 12
    v_add_u32 v177, s42, v11
    s_lshl_b32 s42, s39, 11
    s_add_u32 s42, s42, 81920
    v_add_u32 v176, s42, v11
    s_mov_b32 s60, 4
    s_mov_b32 s61, 0
    s_mov_b32 s40, 1
    v_mov_b32 v178, 0
    v_bfe_u32 v238, v0, 3, 1
    v_lshrrev_b32 v239, 5, v0
    v_cmp_eq_u32 vcc, v238, v239
    v_lshl_add_u32 v238, v238, 1, v239
    v_lshlrev_b32 v231, 1, v238
    v_and_b32 v239, 1, v0
    v_lshlrev_b32 v239, 4, v239
    v_mov_b32 v241, 0x3f80
    v_lshlrev_b32 v239, v239, v241
    v_cndmask_b32 v239, 0, v239, vcc
    s_mov_b32 vcc_lo, 0xf0f0f0f0
    s_mov_b32 vcc_hi, vcc_lo
    v_cndmask_b32 v129, 0, v239, vcc
    v_sub_u32 v128, v239, v129
    v_mov_b32 v131, v129
    v_mov_b32 v130, v128
    s_mov_b32 vcc_lo, 0xcccccccc
    s_mov_b32 vcc_hi, vcc_lo
    v_mov_b32 v239, 0xeeeeeeee
    v_mov_b32 v132, 0x44444444
    v_cndmask_b32 v132, v132, v239, vcc
    v_mov_b32 v228, 0
    v_mov_b32 v229, 0
    v_mov_b32 v230, 0
    v_mov_b32 v108, 0
    v_mov_b32 v109, 0
    v_mov_b32 v110, 0
    v_mov_b32 v111, 0
    v_mov_b32 v112, 0
    v_mov_b32 v113, 0
    v_mov_b32 v114, 0
    v_mov_b32 v115, 0
    v_mov_b32 v116, 0
    v_mov_b32 v117, 0
    v_mov_b32 v118, 0
    v_mov_b32 v119, 0
    v_mov_b32 v120, 0
    v_mov_b32 v121, 0
    v_mov_b32 v122, 0
    v_mov_b32 v123, 0
    v_mov_b32 v124, 0
    v_mov_b32 v125, 0
    v_mov_b32 v126, 0
    v_mov_b32 v127, 0
    v_and_b32 v239, 7, v0
    v_lshlrev_b32 v89, 4, v239
    v_bfe_u32 v241, v0, 4, 1
    v_lshl_add_u32 v241, v241, 3, v89
    v_mul_u32_u24 v237, 144, v238
    s_mul_i32 s42, s39, 1440
    s_add_u32 s42, s42, 131072
    v_add3_u32 v237, v237, v241, s42
    v_lshl_add_u32 v241, v238, 7, v241
    v_mov_b32 v91, v89
    v_mov_b32 v93, v89
    v_mov_b32 v95, v89
    v_mov_b32 v97, v89
    v_mov_b32 v99, v89
    v_mov_b32 v101, v89
    v_mov_b32 v103, v89
    v_mov_b32 v105, v89
    v_mov_b32 v107, v89
    v_mov_b32 v235, 137664
    s_mul_i32 s42, s39, 2560
    s_add_u32 s42, s42, 138176
    v_lshrrev_b32 v238, 3, v0
    v_lshl_add_u32 v233, v238, 1, s42
    v_mov_b32 v236, 2
    v_mov_b32 v234, 16
    v_lshlrev_b32 v232, 7, v2
    v_lshrrev_b32 v242, 2, v0
    v_lshlrev_b32 v242, 14, v242
    v_and_b32 v239, 3, v0
    v_lshl_add_u32 v242, v239, 4, v242
    v_lshlrev_b32 v152, 18, v0
    v_add_u32 v152, 0x1000000, v152
    v_mov_b32 v153, v152
    v_mov_b32 v154, v152
    v_mov_b32 v155, v152
    v_and_b32 v16, 15, v0
    v_and_b32 v17, 48, v0
    s_lshr_b32 s42, s39, 1
    v_lshl_add_u32 v19, s42, 4, v16
    s_cmp_ge_u32 s3, 4
    s_cselect_b32 s54, 0, 256
    s_lshl_b32 s55, s54, 4
    s_add_u32 s54, s54, 137024
    s_add_u32 s55, s55, 150464
    v_lshl_add_u32 v249, v19, 2, s54
    v_lshl_add_u32 v250, v19, 4, s55
    v_lshl_add_u32 v250, v17, 5, v250
    v_or_b32 v251, 32, v0
    v_lshl_add_u32 v251, v251, 2, v15
    v_and_b32 v18, 7, v16
    v_and_b32 v13, 8, v16
    v_lshl_add_u32 v13, v13, 1, v18
    v_lshl_add_u32 v13, v17, 1, v13
    v_lshlrev_b32 v13, 4, v13
    v_add_u32 v18, 32, v18
    s_cmp_ge_u32 s3, 4
    s_cselect_b64 vcc, -1, 0
    v_cndmask_b32 v16, v19, v18, vcc
    v_lshrrev_b32 v19, 3, v19
    v_cmp_eq_u32 s[54:55], s34, v19
    v_mul_u32_u24 v1, 144, v16
    v_add_u32 v1, v1, v17
    v_add_u32 v1, 131072, v1
    v_lshl_add_u32 v12, v16, 7, v17
    s_andn2_b64 vcc, vcc, s[54:55]
    s_and_b32 s54, s39, 1
    s_mul_i32 s42, s33, 80
    s_add_u32 s42, s42, s54
    s_lshl_b32 s42, s42, 6
    v_add_u32 v12, s42, v12
    v_mov_b32 v18, 0x70000000
    v_cndmask_b32 v12, v12, v18, vcc
    s_lshl_b32 s42, s54, 12
    v_add_u32 v13, s42, v13
    s_lshl_b32 s42, s39, 13
    s_add_u32 s42, s42, 81920
    v_add_u32 v14, s42, v11
    s_load_dwordx2 s[6:7], s[0:1], 24
    s_cmp_ge_u32 s33, 250
    s_cbranch_scc1 B_3
    s_waitcnt vmcnt(0) lgkmcnt(0)
    v_mul_u32_u24 v52, s47, v76
    v_lshrrev_b32 v72, 21, v52
    v_mad_u32_u24 v52, v72, v10, s49
    ds_add_rtn_u32 v40, v52, v6
    v_mul_u32_u24 v72, 40, v72
    v_sub_u32 v76, v76, v72
    v_mul_u32_u24 v53, s47, v77
    v_lshrrev_b32 v72, 21, v53
    v_mad_u32_u24 v53, v72, v10, s49
    ds_add_rtn_u32 v41, v53, v6
    v_mul_u32_u24 v72, 40, v72
    v_sub_u32 v77, v77, v72
    v_mul_u32_u24 v54, s47, v78
    v_lshrrev_b32 v72, 21, v54
    v_mad_u32_u24 v54, v72, v10, s49
    ds_add_rtn_u32 v42, v54, v6
    v_mul_u32_u24 v72, 40, v72
    v_sub_u32 v78, v78, v72
    v_mul_u32_u24 v55, s47, v79
    v_lshrrev_b32 v72, 21, v55
    v_mad_u32_u24 v55, v72, v10, s49
    ds_add_rtn_u32 v43, v55, v6
    v_mul_u32_u24 v72, 40, v72
    v_sub_u32 v79, v79, v72
    v_mul_u32_u24 v56, s47, v80
    v_lshrrev_b32 v72, 21, v56
    v_mad_u32_u24 v56, v72, v10, s49
    ds_add_rtn_u32 v44, v56, v6
    v_mul_u32_u24 v72, 40, v72
    v_sub_u32 v80, v80, v72
    v_mul_u32_u24 v57, s47, v81
    v_lshrrev_b32 v72, 21, v57
    v_mad_u32_u24 v57, v72, v10, s49
    ds_add_rtn_u32 v45, v57, v6
    v_mul_u32_u24 v72, 40, v72
    v_sub_u32 v81, v81, v72
    v_mul_u32_u24 v58, s47, v82
    v_lshrrev_b32 v72, 21, v58
    v_mad_u32_u24 v58, v72, v10, s49
    ds_add_rtn_u32 v46, v58, v6
    v_mul_u32_u24 v72, 40, v72
    v_sub_u32 v82, v82, v72
    v_mul_u32_u24 v59, s47, v83
    v_lshrrev_b32 v72, 21, v59
    v_mad_u32_u24 v59, v72, v10, s49
    ds_add_rtn_u32 v47, v59, v6
    v_mul_u32_u24 v72, 40, v72
    v_sub_u32 v83, v83, v72
    v_mul_u32_u24 v60, s47, v84
    v_lshrrev_b32 v72, 21, v60
    v_mad_u32_u24 v60, v72, v10, s49
    ds_add_rtn_u32 v48, v60, v6
    v_mul_u32_u24 v72, 40, v72
    v_sub_u32 v84, v84, v72
    v_mul_u32_u24 v61, s47, v85
    v_lshrrev_b32 v72, 21, v61
    v_mad_u32_u24 v61, v72, v10, s49
    ds_add_rtn_u32 v49, v61, v6
    v_mul_u32_u24 v72, 40, v72
    v_sub_u32 v85, v85, v72
    s_waitcnt lgkmcnt(9)
    v_min_u32_sdwa v40, v40, v7 dst_sel:DWORD dst_unused:UNUSED_PAD src0_sel:WORD_0 src1_sel:DWORD
    v_lshl_add_u32 v52, v40, 2, v52
    s_waitcnt lgkmcnt(8)
    v_min_u32_sdwa v41, v41, v7 dst_sel:DWORD dst_unused:UNUSED_PAD src0_sel:WORD_0 src1_sel:DWORD
    v_lshl_add_u32 v53, v41, 2, v53
    s_waitcnt lgkmcnt(7)
    v_min_u32_sdwa v42, v42, v7 dst_sel:DWORD dst_unused:UNUSED_PAD src0_sel:WORD_0 src1_sel:DWORD
    v_lshl_add_u32 v54, v42, 2, v54
    s_waitcnt lgkmcnt(6)
    v_min_u32_sdwa v43, v43, v7 dst_sel:DWORD dst_unused:UNUSED_PAD src0_sel:WORD_0 src1_sel:DWORD
    v_lshl_add_u32 v55, v43, 2, v55
    s_waitcnt lgkmcnt(5)
    v_min_u32_sdwa v44, v44, v7 dst_sel:DWORD dst_unused:UNUSED_PAD src0_sel:WORD_0 src1_sel:DWORD
    v_lshl_add_u32 v56, v44, 2, v56
    s_waitcnt lgkmcnt(4)
    v_min_u32_sdwa v45, v45, v7 dst_sel:DWORD dst_unused:UNUSED_PAD src0_sel:WORD_0 src1_sel:DWORD
    v_lshl_add_u32 v57, v45, 2, v57
    s_waitcnt lgkmcnt(3)
    v_min_u32_sdwa v46, v46, v7 dst_sel:DWORD dst_unused:UNUSED_PAD src0_sel:WORD_0 src1_sel:DWORD
    v_lshl_add_u32 v58, v46, 2, v58
    s_waitcnt lgkmcnt(2)
    v_min_u32_sdwa v47, v47, v7 dst_sel:DWORD dst_unused:UNUSED_PAD src0_sel:WORD_0 src1_sel:DWORD
    v_lshl_add_u32 v59, v47, 2, v59
    s_waitcnt lgkmcnt(1)
    v_min_u32_sdwa v48, v48, v7 dst_sel:DWORD dst_unused:UNUSED_PAD src0_sel:WORD_0 src1_sel:DWORD
    v_lshl_add_u32 v60, v48, 2, v60
    s_waitcnt lgkmcnt(0)
    v_min_u32_sdwa v49, v49, v7 dst_sel:DWORD dst_unused:UNUSED_PAD src0_sel:WORD_0 src1_sel:DWORD
    v_lshl_add_u32 v61, v49, 2, v61
    s_mov_b32 s58, 800000
B_WG:
    ds_read_b32 v5, v15 offset:40
    s_waitcnt lgkmcnt(0)
    v_readfirstlane_b32 s57, v5
    s_sub_u32 s58, s58, 1
    s_cbranch_scc1 B_WG_X
    s_cmp_lt_u32 s57, 4
    s_cbranch_scc1 B_WG
B_WG_X:
    buffer_load_dwordx4 v[28:31], v3, s[24:27], s50 offen
    buffer_load_dwordx4 v[32:35], v3, s[24:27], s43 offen
    buffer_load_dwordx2 v[36:37], v4, s[24:27], s44 offen
    s_waitcnt vmcnt(0)
    v_lshl_or_b32 v28, v76, 18, v28
    ds_write_b32 v52, v28
    v_lshl_or_b32 v29, v77, 18, v29
    ds_write_b32 v53, v29
    v_lshl_or_b32 v30, v78, 18, v30
    ds_write_b32 v54, v30
    v_lshl_or_b32 v31, v79, 18, v31
    ds_write_b32 v55, v31
    v_lshl_or_b32 v32, v80, 18, v32
    ds_write_b32 v56, v32
    v_lshl_or_b32 v33, v81, 18, v33
    ds_write_b32 v57, v33
    v_lshl_or_b32 v34, v82, 18, v34
    ds_write_b32 v58, v34
    v_lshl_or_b32 v35, v83, 18, v35
    ds_write_b32 v59, v35
    v_lshl_or_b32 v36, v84, 18, v36
    ds_write_b32 v60, v36
    v_lshl_or_b32 v37, v85, 18, v37
    ds_write_b32 v61, v37
    s_mov_b64 exec, 1
    ds_add_u32 v15, v6 offset:32
    s_mov_b64 exec, -1
    s_lshl_b32 s42, s33, 14
    s_add_u32 s43, s42, 0x400000
    s_mov_b32 s58, 800000
B_W1:
    ds_read_b32 v5, v15 offset:32
    s_waitcnt lgkmcnt(0)
    v_readfirstlane_b32 s57, v5
    s_sub_u32 s58, s58, 1
    s_cbranch_scc1 B_W1_X
    s_cmp_lt_u32 s57, 4
    s_cbranch_scc1 B_W1
B_W1_X:
    ds_read_b128 v[16:19], v73 offset:0
    ds_read_b128 v[20:23], v73 offset:9216
    ds_read_b128 v[24:27], v73 offset:18432
    ds_read_b128 v[28:31], v73 offset:27648
    ds_read_b128 v[32:35], v73 offset:64
    ds_read_b128 v[36:39], v73 offset:9280
    ds_read_b128 v[40:43], v73 offset:18496
    ds_read_b128 v[44:47], v73 offset:27712
    v_mov_b32 v7, 16
    s_waitcnt lgkmcnt(7)
    buffer_store_dwordx4 v[16:19], v3, s[28:31], s42 offen sc1
    v_mov_b32_dpp v48, v16 quad_perm:[0,0,0,0] row_mask:0xf bank_mask:0xf
    s_add_u32 s42, s42, 0x1000
    s_waitcnt lgkmcnt(6)
    buffer_store_dwordx4 v[20:23], v3, s[28:31], s42 offen sc1
    v_mov_b32_dpp v49, v20 quad_perm:[0,0,0,0] row_mask:0xf bank_mask:0xf
    s_add_u32 s42, s42, 0x1000
    s_waitcnt lgkmcnt(5)
    buffer_store_dwordx4 v[24:27], v3, s[28:31], s42 offen sc1
    v_mov_b32_dpp v50, v24 quad_perm:[0,0,0,0] row_mask:0xf bank_mask:0xf
    s_add_u32 s42, s42, 0x1000
    s_waitcnt lgkmcnt(4)
    buffer_store_dwordx4 v[28:31], v3, s[28:31], s42 offen sc1
    v_mov_b32_dpp v51, v28 quad_perm:[0,0,0,0] row_mask:0xf bank_mask:0xf
    s_add_u32 s42, s42, 0x1000
    s_waitcnt lgkmcnt(0)
    v_cmp_gt_u32_sdwa vcc, v48, v7 src0_sel:WORD_0 src1_sel:DWORD
    s_and_b64 exec, vcc, -1
    s_cbranch_scc0 B_O0
    buffer_store_dwordx4 v[32:35], v3, s[28:31], s43 offen sc1
B_O0:
    s_mov_b64 exec, -1
    s_add_u32 s43, s43, 0x1000
    v_cmp_gt_u32_sdwa vcc, v49, v7 src0_sel:WORD_0 src1_sel:DWORD
    s_and_b64 exec, vcc, -1
    s_cbranch_scc0 B_O1
    buffer_store_dwordx4 v[36:39], v3, s[28:31], s43 offen sc1
B_O1:
    s_mov_b64 exec, -1
    s_add_u32 s43, s43, 0x1000
    v_cmp_gt_u32_sdwa vcc, v50, v7 src0_sel:WORD_0 src1_sel:DWORD
    s_and_b64 exec, vcc, -1
    s_cbranch_scc0 B_O2
    buffer_store_dwordx4 v[40:43], v3, s[28:31], s43 offen sc1
B_O2:
    s_mov_b64 exec, -1
    s_add_u32 s43, s43, 0x1000
    v_cmp_gt_u32_sdwa vcc, v51, v7 src0_sel:WORD_0 src1_sel:DWORD
    s_and_b64 exec, vcc, -1
    s_cbranch_scc0 B_O3
    buffer_store_dwordx4 v[44:47], v3, s[28:31], s43 offen sc1
B_O3:
    s_mov_b64 exec, -1
    s_add_u32 s43, s43, 0x1000
B_3:
    s_lshl_b32 s42, s33, 7
    s_lshl2_add_u32 s42, s39, s42
    s_add_u32 s42, s42, 32768
    v_mov_b32 v5, s35
    s_mov_b64 exec, 1
    s_waitcnt lgkmcnt(0)
    ds_add_u32 v15, v6 offset:36
    s_waitcnt vmcnt(0)
    buffer_store_dword v5, off, s[12:15], s42 sc1
    s_mov_b64 exec, -1
B_4:
    s_add_u32 s8, s4, 0x300000
    s_addc_u32 s9, s5, 0
    s_mov_b32 s10, 0x800000
    s_mov_b32 s11, 0x20000
    v_mov_b32 v183, s35
    v_mov_b32 v187, s35
    v_mov_b32 v191, s35
    s_cmp_ge_u32 s33, 250
    s_cbranch_scc1 B_X
    s_mov_b32 s16, s4
    s_mov_b32 s17, s5
    s_or_b32 s17, s17, 0x800000
    s_mov_b32 s18, 0x2710
    s_mov_b32 s19, 0x20000
    s_mov_b32 s48, s6
    s_mov_b32 s49, s7
    s_mov_b32 s50, 0x4e20
    s_mov_b32 s51, 0x20000
    s_mul_i32 s42, s33, 80
    s_mul_i32 s43, s39, 20
    s_add_u32 s42, s42, s43
    buffer_load_short_d16_hi v228, v231, s[48:51], s42 offen offset:0
    buffer_load_short_d16_hi v229, v231, s[48:51], s42 offen offset:8
    buffer_load_short_d16_hi v230, v231, s[48:51], s42 offen offset:16
    s_lshl_b32 s44, s39, 20
    s_lshl_b32 s45, s33, 6
    s_add_u32 s44, s44, s45
    s_cmp_eq_u32 s39, 3
    s_cselect_b32 s47, 0xff, -1
    s_and_b32 s45, s2, 31
    s_lshl2_add_u32 s45, s45, s39
    s_lshl_b32 s45, s45, 7
    s_mov_b32 s58, 100000
B_PS:
    s_buffer_load_dword s52, s[12:15], s45 offset:65536 glc
    s_sub_u32 s58, s58, 1
    s_cbranch_scc1 B_PS_X
    s_waitcnt lgkmcnt(0)
    s_cmp_lg_u32 s52, s35
    s_cbranch_scc1 B_PS
B_PS_X:
    s_waitcnt lgkmcnt(0)
    s_setprio 2
    buffer_load_dwordx4 v[140:143], v242, s[28:31], s44 offen sc1
    s_add_u32 s44, s44, 0x40000
    buffer_load_dwordx4 v[144:147], v242, s[28:31], s44 offen sc1
    s_add_u32 s44, s44, 0x40000
    buffer_load_dwordx4 v[148:151], v242, s[28:31], s44 offen sc1
    s_add_u32 s44, s44, 0x40000
    s_mov_b32 exec_hi, s47
    buffer_load_dwordx4 v[152:155], v242, s[28:31], s44 offen sc1
    s_add_u32 s44, s44, 0x40000
    s_mov_b64 exec, -1
    s_add_u32 s44, s44, 0x300000
    s_waitcnt vmcnt(0)
    v_mov_b32_dpp v244, v140 quad_perm:[0,0,0,0] row_mask:0xf bank_mask:0xf
    v_mov_b32_dpp v245, v144 quad_perm:[0,0,0,0] row_mask:0xf bank_mask:0xf
    v_mov_b32_dpp v246, v148 quad_perm:[0,0,0,0] row_mask:0xf bank_mask:0xf
    v_mov_b32_dpp v247, v152 quad_perm:[0,0,0,0] row_mask:0xf bank_mask:0xf
    v_and_b32 v244, 0xffff, v244
    v_and_b32 v245, 0xffff, v245
    v_and_b32 v246, 0xffff, v246
    v_and_b32 v247, 0xffff, v247
    v_cmp_gt_u32 s[52:53], v244, v234
    v_cmp_gt_u32 s[54:55], v245, v234
    v_cmp_gt_u32 s[56:57], v246, v234
    v_cmp_gt_u32 s[58:59], v247, v234
    v_max3_u32 v239, v244, v245, v246
    v_max_u32 v239, v239, v247
    v_cmp_lt_u32 vcc, 32, v239
    v_mov_b32 v239, 0x101
    s_cbranch_vccnz G_SYNC
    s_and_b64 exec, s[52:53], -1
    s_cbranch_scc0 G_O0
    buffer_load_dwordx4 v[156:159], v242, s[28:31], s44 offen sc1
G_O0:
    s_add_u32 s44, s44, 0x40000
    s_and_b64 exec, s[54:55], -1
    s_cbranch_scc0 G_O1
    buffer_load_dwordx4 v[160:163], v242, s[28:31], s44 offen sc1
G_O1:
    s_add_u32 s44, s44, 0x40000
    s_and_b64 exec, s[56:57], -1
    s_cbranch_scc0 G_O2
    buffer_load_dwordx4 v[164:167], v242, s[28:31], s44 offen sc1
G_O2:
    s_add_u32 s44, s44, 0x40000
    s_and_b64 exec, s[58:59], -1
    s_cbranch_scc0 G_O3
    buffer_load_dwordx4 v[168:171], v242, s[28:31], s44 offen sc1
G_O3:
    s_add_u32 s44, s44, 0x40000
    s_mov_b64 exec, -1
    v_add_u32_sdwa v16, v140, v235 dst_sel:DWORD dst_unused:UNUSED_PAD src0_sel:WORD_1 src1_sel:DWORD
    v_add_u32_sdwa v17, v141, v235 dst_sel:DWORD dst_unused:UNUSED_PAD src0_sel:WORD_1 src1_sel:DWORD
    v_add_u32_sdwa v18, v142, v235 dst_sel:DWORD dst_unused:UNUSED_PAD src0_sel:WORD_1 src1_sel:DWORD
    v_add_u32_sdwa v19, v143, v235 dst_sel:DWORD dst_unused:UNUSED_PAD src0_sel:WORD_1 src1_sel:DWORD
    v_add_u32_sdwa v20, v144, v235 dst_sel:DWORD dst_unused:UNUSED_PAD src0_sel:WORD_1 src1_sel:DWORD
    v_add_u32_sdwa v21, v145, v235 dst_sel:DWORD dst_unused:UNUSED_PAD src0_sel:WORD_1 src1_sel:DWORD
    v_add_u32_sdwa v22, v146, v235 dst_sel:DWORD dst_unused:UNUSED_PAD src0_sel:WORD_1 src1_sel:DWORD
    v_add_u32_sdwa v23, v147, v235 dst_sel:DWORD dst_unused:UNUSED_PAD src0_sel:WORD_1 src1_sel:DWORD
    v_add_u32_sdwa v24, v148, v235 dst_sel:DWORD dst_unused:UNUSED_PAD src0_sel:WORD_1 src1_sel:DWORD
    v_add_u32_sdwa v25, v149, v235 dst_sel:DWORD dst_unused:UNUSED_PAD src0_sel:WORD_1 src1_sel:DWORD
    v_add_u32_sdwa v26, v150, v235 dst_sel:DWORD dst_unused:UNUSED_PAD src0_sel:WORD_1 src1_sel:DWORD
    v_add_u32_sdwa v27, v151, v235 dst_sel:DWORD dst_unused:UNUSED_PAD src0_sel:WORD_1 src1_sel:DWORD
    v_add_u32_sdwa v28, v152, v235 dst_sel:DWORD dst_unused:UNUSED_PAD src0_sel:WORD_1 src1_sel:DWORD
    v_add_u32_sdwa v29, v153, v235 dst_sel:DWORD dst_unused:UNUSED_PAD src0_sel:WORD_1 src1_sel:DWORD
    v_add_u32_sdwa v30, v154, v235 dst_sel:DWORD dst_unused:UNUSED_PAD src0_sel:WORD_1 src1_sel:DWORD
    v_add_u32_sdwa v31, v155, v235 dst_sel:DWORD dst_unused:UNUSED_PAD src0_sel:WORD_1 src1_sel:DWORD
    v_mov_b32 v239, 1
    s_setprio 0
    ds_add_rtn_u32 v16, v16, v236
    ds_add_rtn_u32 v17, v17, v236
    s_waitcnt lgkmcnt(0)
    ds_add_rtn_u32 v18, v18, v236
    ds_add_rtn_u32 v19, v19, v236
    ds_write_b16 v16, v140
    ds_write_b16 v17, v141
    s_waitcnt lgkmcnt(0)
    ds_add_rtn_u32 v20, v20, v236
    ds_add_rtn_u32 v21, v21, v236
    ds_write_b16 v18, v142
    ds_write_b16 v19, v143
    s_waitcnt lgkmcnt(0)
    ds_add_rtn_u32 v22, v22, v236
    ds_add_rtn_u32 v23, v23, v236
    ds_write_b16 v20, v144
    ds_write_b16 v21, v145
    s_waitcnt lgkmcnt(0)
    ds_add_rtn_u32 v24, v24, v236
    ds_add_rtn_u32 v25, v25, v236
    ds_write_b16 v22, v146
    ds_write_b16 v23, v147
    s_waitcnt lgkmcnt(0)
    ds_add_rtn_u32 v26, v26, v236
    ds_add_rtn_u32 v27, v27, v236
    ds_write_b16 v24, v148
    ds_write_b16 v25, v149
    s_waitcnt lgkmcnt(0)
    ds_add_rtn_u32 v28, v28, v236
    ds_add_rtn_u32 v29, v29, v236
    ds_write_b16 v26, v150
    ds_write_b16 v27, v151
    s_waitcnt lgkmcnt(0)
    ds_add_rtn_u32 v30, v30, v236
    ds_add_rtn_u32 v31, v31, v236
    ds_write_b16 v28, v152
    ds_write_b16 v29, v153
    s_waitcnt lgkmcnt(0)
    ds_write_b16 v30, v154
    ds_write_b16 v31, v155
    s_waitcnt vmcnt(0)
    s_and_b64 exec, s[52:53], -1
    s_cbranch_scc0 G_P0
    s_setprio 2
    v_add_u32_sdwa v32, v156, v235 dst_sel:DWORD dst_unused:UNUSED_PAD src0_sel:WORD_1 src1_sel:DWORD
    v_add_u32_sdwa v33, v157, v235 dst_sel:DWORD dst_unused:UNUSED_PAD src0_sel:WORD_1 src1_sel:DWORD
    v_add_u32_sdwa v34, v158, v235 dst_sel:DWORD dst_unused:UNUSED_PAD src0_sel:WORD_1 src1_sel:DWORD
    v_add_u32_sdwa v35, v159, v235 dst_sel:DWORD dst_unused:UNUSED_PAD src0_sel:WORD_1 src1_sel:DWORD
    s_setprio 0
    ds_add_rtn_u32 v32, v32, v236
    ds_add_rtn_u32 v33, v33, v236
    ds_add_rtn_u32 v34, v34, v236
    ds_add_rtn_u32 v35, v35, v236
    s_waitcnt lgkmcnt(0)
    ds_write_b16 v32, v156
    ds_write_b16 v33, v157
    ds_write_b16 v34, v158
    ds_write_b16 v35, v159
G_P0:
    s_and_b64 exec, s[54:55], -1
    s_cbranch_scc0 G_P1
    s_setprio 2
    v_add_u32_sdwa v36, v160, v235 dst_sel:DWORD dst_unused:UNUSED_PAD src0_sel:WORD_1 src1_sel:DWORD
    v_add_u32_sdwa v37, v161, v235 dst_sel:DWORD dst_unused:UNUSED_PAD src0_sel:WORD_1 src1_sel:DWORD
    v_add_u32_sdwa v38, v162, v235 dst_sel:DWORD dst_unused:UNUSED_PAD src0_sel:WORD_1 src1_sel:DWORD
    v_add_u32_sdwa v39, v163, v235 dst_sel:DWORD dst_unused:UNUSED_PAD src0_sel:WORD_1 src1_sel:DWORD
    s_setprio 0
    ds_add_rtn_u32 v36, v36, v236
    ds_add_rtn_u32 v37, v37, v236
    ds_add_rtn_u32 v38, v38, v236
    ds_add_rtn_u32 v39, v39, v236
    s_waitcnt lgkmcnt(0)
    ds_write_b16 v36, v160
    ds_write_b16 v37, v161
    ds_write_b16 v38, v162
    ds_write_b16 v39, v163
G_P1:
    s_and_b64 exec, s[56:57], -1
    s_cbranch_scc0 G_P2
    s_setprio 2
    v_add_u32_sdwa v40, v164, v235 dst_sel:DWORD dst_unused:UNUSED_PAD src0_sel:WORD_1 src1_sel:DWORD
    v_add_u32_sdwa v41, v165, v235 dst_sel:DWORD dst_unused:UNUSED_PAD src0_sel:WORD_1 src1_sel:DWORD
    v_add_u32_sdwa v42, v166, v235 dst_sel:DWORD dst_unused:UNUSED_PAD src0_sel:WORD_1 src1_sel:DWORD
    v_add_u32_sdwa v43, v167, v235 dst_sel:DWORD dst_unused:UNUSED_PAD src0_sel:WORD_1 src1_sel:DWORD
    s_setprio 0
    ds_add_rtn_u32 v40, v40, v236
    ds_add_rtn_u32 v41, v41, v236
    ds_add_rtn_u32 v42, v42, v236
    ds_add_rtn_u32 v43, v43, v236
    s_waitcnt lgkmcnt(0)
    ds_write_b16 v40, v164
    ds_write_b16 v41, v165
    ds_write_b16 v42, v166
    ds_write_b16 v43, v167
G_P2:
    s_and_b64 exec, s[58:59], -1
    s_cbranch_scc0 G_P3
    s_setprio 2
    v_add_u32_sdwa v44, v168, v235 dst_sel:DWORD dst_unused:UNUSED_PAD src0_sel:WORD_1 src1_sel:DWORD
    v_add_u32_sdwa v45, v169, v235 dst_sel:DWORD dst_unused:UNUSED_PAD src0_sel:WORD_1 src1_sel:DWORD
    v_add_u32_sdwa v46, v170, v235 dst_sel:DWORD dst_unused:UNUSED_PAD src0_sel:WORD_1 src1_sel:DWORD
    v_add_u32_sdwa v47, v171, v235 dst_sel:DWORD dst_unused:UNUSED_PAD src0_sel:WORD_1 src1_sel:DWORD
    s_setprio 0
    ds_add_rtn_u32 v44, v44, v236
    ds_add_rtn_u32 v45, v45, v236
    ds_add_rtn_u32 v46, v46, v236
    ds_add_rtn_u32 v47, v47, v236
    s_waitcnt lgkmcnt(0)
    ds_write_b16 v44, v168
    ds_write_b16 v45, v169
    ds_write_b16 v46, v170
    ds_write_b16 v47, v171
G_P3:
    s_mov_b64 exec, -1
G_SYNC:
    s_waitcnt vmcnt(0)
    s_mov_b64 exec, 1
    ds_add_u32 v15, v239 offset:4
    s_mov_b64 exec, -1
    s_mov_b32 s58, 800000
G_S1:
    ds_read_b32 v239, v15 offset:4
    s_waitcnt lgkmcnt(0)
    v_readfirstlane_b32 s57, v239
    s_sub_u32 s58, s58, 1
    s_cbranch_scc1 G_S1_X
    s_and_b32 s59, s57, 0xff
    s_cmp_lt_u32 s59, 4
    s_cbranch_scc1 G_S1
G_S1_X:
    s_cmp_gt_u32 s57, 0xff
    s_cbranch_scc1 G_SLOW
    ds_read_b32 v239, v8
    ds_read_u16 v88, v233 offset:0
    ds_read_u16 v90, v233 offset:256
    ds_read_u16 v92, v233 offset:512
    ds_read_u16 v94, v233 offset:768
    ds_read_u16 v96, v233 offset:1024
    ds_read_u16 v98, v233 offset:1280
    ds_read_u16 v100, v233 offset:1536
    ds_read_u16 v102, v233 offset:1792
    ds_read_u16 v104, v233 offset:2048
    ds_read_u16 v106, v233 offset:2304
    s_mul_i32 s43, s39, 10
    s_bfm_b64 s[52:53], 10, s43
    s_waitcnt lgkmcnt(10)
    v_sub_u32 v239, v239, v9
    v_cmp_lt_u32 vcc, 0x100, v239
    s_cbranch_vccnz G_SLOW
    s_waitcnt vmcnt(5) lgkmcnt(9)
    buffer_load_dwordx4 v[48:51], v[88:89], s[16:19], 0 idxen offen sc1
    ds_read_u16 v88, v233 offset:16
    s_waitcnt vmcnt(5) lgkmcnt(9)
    buffer_load_dwordx4 v[52:55], v[90:91], s[16:19], 0 idxen offen sc1
    ds_read_u16 v90, v233 offset:272
    s_waitcnt vmcnt(5) lgkmcnt(9)
    buffer_load_dwordx4 v[56:59], v[92:93], s[16:19], 0 idxen offen sc1
    ds_read_u16 v92, v233 offset:528
    s_waitcnt vmcnt(5) lgkmcnt(9)
    buffer_load_dwordx4 v[60:63], v[94:95], s[16:19], 0 idxen offen sc1
    ds_read_u16 v94, v233 offset:784
    s_waitcnt vmcnt(5) lgkmcnt(9)
    buffer_load_dwordx4 v[64:67], v[96:97], s[16:19], 0 idxen offen sc1
    ds_read_u16 v96, v233 offset:1040
    s_waitcnt vmcnt(5) lgkmcnt(9)
    buffer_load_dwordx4 v[68:71], v[98:99], s[16:19], 0 idxen offen sc1
    ds_read_u16 v98, v233 offset:1296
    s_waitcnt vmcnt(5) lgkmcnt(9)
    buffer_load_dwordx4 v[72:75], v[100:101], s[16:19], 0 idxen offen sc1
    ds_read_u16 v100, v233 offset:1552
    s_waitcnt vmcnt(5) lgkmcnt(9)
    buffer_load_dwordx4 v[76:79], v[102:103], s[16:19], 0 idxen offen sc1
    ds_read_u16 v102, v233 offset:1808
    s_waitcnt vmcnt(5) lgkmcnt(9)
    buffer_load_dwordx4 v[80:83], v[104:105], s[16:19], 0 idxen offen sc1
    ds_read_u16 v104, v233 offset:2064
    s_waitcnt vmcnt(5) lgkmcnt(9)
    buffer_load_dwordx4 v[84:87], v[106:107], s[16:19], 0 idxen offen sc1
    ds_read_u16 v106, v233 offset:2320
    s_mov_b32 s56, 16
G_LOOP:
    v_cmp_lt_u32 vcc, s56, v239
    v_readfirstlane_b32 s57, v178
    ds_read_b32 v178, v15 offset:8
    s_add_u32 s56, s56, 16
    s_and_b64 vcc, vcc, s[52:53]
    s_cbranch_scc0 G_DRAIN
    s_cmp_ge_u32 s57, s60
    s_cbranch_scc1 X_H
G_RET:
    s_waitcnt vmcnt(4) lgkmcnt(8)
    v_smfmac_f32_16x16x64_bf16 v[108:111], v[128:131], v[48:55], v132
    buffer_load_dwordx4 v[48:51], v[88:89], s[16:19], 0 idxen offen sc1
    ds_read_u16 v88, v233 offset:32
    buffer_load_dwordx4 v[52:55], v[90:91], s[16:19], 0 idxen offen sc1
    ds_read_u16 v90, v233 offset:288
    s_waitcnt vmcnt(4) lgkmcnt(8)
    v_smfmac_f32_16x16x64_bf16 v[112:115], v[128:131], v[56:63], v132
    buffer_load_dwordx4 v[56:59], v[92:93], s[16:19], 0 idxen offen sc1
    ds_read_u16 v92, v233 offset:544
    buffer_load_dwordx4 v[60:63], v[94:95], s[16:19], 0 idxen offen sc1
    ds_read_u16 v94, v233 offset:800
    s_waitcnt vmcnt(4) lgkmcnt(8)
    v_smfmac_f32_16x16x64_bf16 v[116:119], v[128:131], v[64:71], v132
    buffer_load_dwordx4 v[64:67], v[96:97], s[16:19], 0 idxen offen sc1
    ds_read_u16 v96, v233 offset:1056
    buffer_load_dwordx4 v[68:71], v[98:99], s[16:19], 0 idxen offen sc1
    ds_read_u16 v98, v233 offset:1312
    s_waitcnt vmcnt(4) lgkmcnt(8)
    v_smfmac_f32_16x16x64_bf16 v[120:123], v[128:131], v[72:79], v132
    buffer_load_dwordx4 v[72:75], v[100:101], s[16:19], 0 idxen offen sc1
    ds_read_u16 v100, v233 offset:1568
    buffer_load_dwordx4 v[76:79], v[102:103], s[16:19], 0 idxen offen sc1
    ds_read_u16 v102, v233 offset:1824
    s_waitcnt vmcnt(4) lgkmcnt(8)
    v_smfmac_f32_16x16x64_bf16 v[124:127], v[128:131], v[80:87], v132
    buffer_load_dwordx4 v[80:83], v[104:105], s[16:19], 0 idxen offen sc1
    ds_read_u16 v104, v233 offset:2080
    buffer_load_dwordx4 v[84:87], v[106:107], s[16:19], 0 idxen offen sc1
    ds_read_u16 v106, v233 offset:2336
    v_add_u32 v233, 16, v233
    s_branch G_LOOP
G_DRAIN:
    s_waitcnt vmcnt(8)
    v_smfmac_f32_16x16x64_bf16 v[108:111], v[128:131], v[48:55], v132
    s_waitcnt vmcnt(6)
    v_smfmac_f32_16x16x64_bf16 v[112:115], v[128:131], v[56:63], v132
    s_waitcnt vmcnt(4)
    v_smfmac_f32_16x16x64_bf16 v[116:119], v[128:131], v[64:71], v132
    s_waitcnt vmcnt(2)
    v_smfmac_f32_16x16x64_bf16 v[120:123], v[128:131], v[72:79], v132
    s_waitcnt vmcnt(0)
    v_smfmac_f32_16x16x64_bf16 v[124:127], v[128:131], v[80:87], v132
    s_cmp_eq_u32 s60, 4
    s_cbranch_scc1 G_NS
    s_xor_b32 s42, s33, 1
    s_lshl_b32 s42, s42, 15
    s_xor_b32 s43, s33, 2
    s_lshl_b32 s43, s43, 15
    s_xor_b32 s44, s33, 3
    s_lshl_b32 s44, s44, 15
    s_mov_b32 s40, 3
    buffer_load_dwordx4 v[48:51], v177, s[8:11], s42 offen offset:0 sc1
    buffer_load_dwordx4 v[52:55], v177, s[8:11], s42 offen offset:1024 sc1
    buffer_load_dwordx4 v[56:59], v177, s[8:11], s42 offen offset:2048 sc1
    buffer_load_dwordx4 v[60:63], v177, s[8:11], s43 offen offset:0 sc1
    buffer_load_dwordx4 v[64:67], v177, s[8:11], s43 offen offset:1024 sc1
    buffer_load_dwordx4 v[68:71], v177, s[8:11], s43 offen offset:2048 sc1
    buffer_load_dwordx4 v[72:75], v177, s[8:11], s44 offen offset:0 sc1
    buffer_load_dwordx4 v[76:79], v177, s[8:11], s44 offen offset:1024 sc1
    buffer_load_dwordx4 v[80:83], v177, s[8:11], s44 offen offset:2048 sc1
G_NS:
    s_nop 7
    v_add_f32_dpp v108, v108, v108 row_ror:8 row_mask:0xf bank_mask:0x3
    v_add_f32_dpp v109, v109, v109 row_ror:8 row_mask:0xf bank_mask:0x3
    v_add_f32_dpp v110, v110, v110 row_ror:8 row_mask:0xf bank_mask:0x3
    v_add_f32_dpp v111, v111, v111 row_ror:8 row_mask:0xf bank_mask:0x3
    v_add_f32_dpp v108, v112, v112 row_ror:8 row_mask:0xf bank_mask:0xc
    v_add_f32_dpp v109, v113, v113 row_ror:8 row_mask:0xf bank_mask:0xc
    v_add_f32_dpp v110, v114, v114 row_ror:8 row_mask:0xf bank_mask:0xc
    v_add_f32_dpp v111, v115, v115 row_ror:8 row_mask:0xf bank_mask:0xc
    v_add_f32_dpp v116, v116, v116 row_ror:8 row_mask:0xf bank_mask:0x3
    v_add_f32_dpp v117, v117, v117 row_ror:8 row_mask:0xf bank_mask:0x3
    v_add_f32_dpp v118, v118, v118 row_ror:8 row_mask:0xf bank_mask:0x3
    v_add_f32_dpp v119, v119, v119 row_ror:8 row_mask:0xf bank_mask:0x3
    v_add_f32_dpp v116, v120, v120 row_ror:8 row_mask:0xf bank_mask:0xc
    v_add_f32_dpp v117, v121, v121 row_ror:8 row_mask:0xf bank_mask:0xc
    v_add_f32_dpp v118, v122, v122 row_ror:8 row_mask:0xf bank_mask:0xc
    v_add_f32_dpp v119, v123, v123 row_ror:8 row_mask:0xf bank_mask:0xc
    v_add_f32_dpp v124, v124, v124 row_ror:8 row_mask:0xf bank_mask:0x3
    v_add_f32_dpp v125, v125, v125 row_ror:8 row_mask:0xf bank_mask:0x3
    v_add_f32_dpp v126, v126, v126 row_ror:8 row_mask:0xf bank_mask:0x3
    v_add_f32_dpp v127, v127, v127 row_ror:8 row_mask:0xf bank_mask:0x3
G_FIN:
    v_mul_f32 v108, v108, v228
    v_mul_f32 v109, v109, v228
    v_mul_f32 v110, v110, v228
    v_mul_f32 v111, v111, v228
    v_cvt_pk_bf16_f32 v108, v108, v109
    v_cvt_pk_bf16_f32 v109, v110, v111
    ds_write_b64 v237, v[108:109] offset:0
    v_mul_f32 v116, v116, v229
    v_mul_f32 v117, v117, v229
    v_mul_f32 v118, v118, v229
    v_mul_f32 v119, v119, v229
    v_cvt_pk_bf16_f32 v116, v116, v117
    v_cvt_pk_bf16_f32 v117, v118, v119
    ds_write_b64 v237, v[116:117] offset:576
    v_mul_f32 v124, v124, v230
    v_mul_f32 v125, v125, v230
    v_mul_f32 v126, v126, v230
    v_mul_f32 v127, v127, v230
    v_cvt_pk_bf16_f32 v124, v124, v125
    v_cvt_pk_bf16_f32 v125, v126, v127
    s_mov_b32 exec_lo, 0x00ff00ff
    s_mov_b32 exec_hi, 0x00ff00ff
    ds_write_b64 v237, v[124:125] offset:1152
    s_mov_b64 exec, -1
B_X:
    s_setprio 2
    s_load_dwordx2 s[6:7], s[0:1], 0
    s_load_dwordx2 s[28:29], s[0:1], 72
    s_waitcnt lgkmcnt(0)
    s_lshl_b32 s54, s34, 3
    s_lshl_b32 s54, 0xff, s54
    s_mov_b32 s55, s54
    s_mov_b32 s16, s6
    s_mov_b32 s17, s7
    s_mov_b32 s18, 0x138800
    s_mov_b32 s19, 0x20000
    s_add_u32 s20, s4, 0x280000
    s_addc_u32 s21, s5, 0
    s_mov_b32 s22, 0x4000
    s_mov_b32 s23, 0x20000
    s_mov_b32 s24, s28
    s_mov_b32 s25, s29
    s_mov_b32 s26, 0x138800
    s_mov_b32 s27, 0x20000
    s_movk_i32 s61, 0x1000
    s_movk_i32 s62, 0x2000
    s_movk_i32 s63, 0x3000
    buffer_load_dwordx4 v[208:211], v13, s[20:23], 0 offen offset:0 sc1
    buffer_load_dwordx4 v[212:215], v13, s[20:23], 0 offen offset:128 sc1
    buffer_load_dwordx4 v[216:219], v13, s[20:23], 0 offen offset:2048 sc1
    buffer_load_dwordx4 v[220:223], v13, s[20:23], 0 offen offset:2176 sc1
    buffer_load_dwordx4 v[224:227], v13, s[20:23], s62 offen offset:0 sc1
    buffer_load_dwordx4 v[228:231], v13, s[20:23], s62 offen offset:128 sc1
    buffer_load_dwordx4 v[232:235], v13, s[20:23], s62 offen offset:2048 sc1
    buffer_load_dwordx4 v[236:239], v13, s[20:23], s62 offen offset:2176 sc1
    buffer_load_dwordx4 v[32:35], v12, s[16:19], 0 offen
    s_lshl_b32 s42, s39, 10
    s_add_u32 s42, s42, 150464
    v_add_u32 v246, s42, v11
    v_lshl_add_u32 v248, v0, 2, v15
X_D:
    s_cmp_lg_u32 s60, 4
    s_cbranch_scc1 X_1
    s_setprio 0
    s_mov_b32 s58, 800000
X_WE:
    ds_read_b32 v140, v15 offset:8
    s_waitcnt lgkmcnt(0)
    v_readfirstlane_b32 s57, v140
    s_sub_u32 s58, s58, 1
    s_cbranch_scc1 X_WE_X
    s_cmp_lt_u32 s57, 4
    s_cbranch_scc1 X_WE
X_WE_X:
    s_branch X_H
X_1:
    s_cmp_eq_u32 s40, 2
    s_cbranch_scc1 X_2
    ds_read_b32 v140, v15 offset:8
    s_waitcnt lgkmcnt(0)
    v_readfirstlane_b32 s57, v140
    s_cmp_ge_u32 s57, s60
    s_cbranch_scc1 X_H
    s_xor_b32 s42, s33, 1
    s_lshl_b32 s42, s42, 15
    s_xor_b32 s43, s33, 2
    s_lshl_b32 s43, s43, 15
    s_xor_b32 s44, s33, 3
    s_lshl_b32 s44, s44, 15
    s_mov_b32 s58, 100000
    s_cmp_eq_u32 s40, 3
    s_mov_b32 s40, 2
    s_cbranch_scc1 X_PE_C
X_PE_P:
    s_lshl_b32 s45, s39, 12
    s_add_u32 s48, s42, s45
    s_add_u32 s49, s43, s45
    s_add_u32 s50, s44, s45
X_QE:
    s_buffer_load_dword s52, s[8:11], s48 offset:3068 glc
    s_buffer_load_dword s53, s[8:11], s49 offset:3068 glc
    s_buffer_load_dword s59, s[8:11], s50 offset:3068 glc
    s_sub_u32 s58, s58, 1
    s_cbranch_scc1 X_QE_X
    s_waitcnt lgkmcnt(0)
    s_cmp_lg_u32 s52, s35
    s_cbranch_scc1 X_QE
    s_cmp_lg_u32 s53, s35
    s_cbranch_scc1 X_QE
    s_cmp_lg_u32 s59, s35
    s_cbranch_scc1 X_QE
X_QE_X:
    s_waitcnt lgkmcnt(0)
    s_max_i32 s58, s58, 0
    buffer_load_dwordx4 v[48:51], v177, s[8:11], s42 offen offset:0 sc1
    buffer_load_dwordx4 v[52:55], v177, s[8:11], s42 offen offset:1024 sc1
    buffer_load_dwordx4 v[56:59], v177, s[8:11], s42 offen offset:2048 sc1
    buffer_load_dwordx4 v[60:63], v177, s[8:11], s43 offen offset:0 sc1
    buffer_load_dwordx4 v[64:67], v177, s[8:11], s43 offen offset:1024 sc1
    buffer_load_dwordx4 v[68:71], v177, s[8:11], s43 offen offset:2048 sc1
    buffer_load_dwordx4 v[72:75], v177, s[8:11], s44 offen offset:0 sc1
    buffer_load_dwordx4 v[76:79], v177, s[8:11], s44 offen offset:1024 sc1
    buffer_load_dwordx4 v[80:83], v177, s[8:11], s44 offen offset:2048 sc1
X_PE_C:
    s_setprio 2
    s_waitcnt vmcnt(0)
    v_cmp_ne_u32 vcc, s35, v51
    v_cmp_ne_u32 s[56:57], s35, v55
    s_or_b64 vcc, vcc, s[56:57]
    v_cmp_ne_u32 s[56:57], s35, v59
    s_or_b64 vcc, vcc, s[56:57]
    v_cmp_ne_u32 s[56:57], s35, v63
    s_or_b64 vcc, vcc, s[56:57]
    v_cmp_ne_u32 s[56:57], s35, v67
    s_or_b64 vcc, vcc, s[56:57]
    v_cmp_ne_u32 s[56:57], s35, v71
    s_or_b64 vcc, vcc, s[56:57]
    v_cmp_ne_u32 s[56:57], s35, v75
    s_or_b64 vcc, vcc, s[56:57]
    v_cmp_ne_u32 s[56:57], s35, v79
    s_or_b64 vcc, vcc, s[56:57]
    v_cmp_ne_u32 s[56:57], s35, v83
    s_or_b64 vcc, vcc, s[56:57]
    s_sub_u32 s58, s58, 1
    s_cbranch_scc1 X_PE_X
    s_cbranch_vccnz X_PE_P
X_PE_X:
    v_add_f32 v48, v48, v192
    v_add_f32 v60, v60, v72
    v_add_f32 v49, v49, v193
    v_add_f32 v61, v61, v73
    v_add_f32 v50, v50, v194
    v_add_f32 v62, v62, v74
    v_add_f32 v52, v52, v195
    v_add_f32 v64, v64, v76
    v_add_f32 v53, v53, v196
    v_add_f32 v65, v65, v77
    v_add_f32 v54, v54, v197
    v_add_f32 v66, v66, v78
    v_add_f32 v56, v56, v198
    v_add_f32 v68, v68, v80
    v_add_f32 v57, v57, v199
    v_add_f32 v69, v69, v81
    v_add_f32 v40, v48, v60
    v_add_f32 v41, v49, v61
    v_add_f32 v42, v50, v62
    v_add_f32 v43, v52, v64
    v_add_f32 v44, v53, v65
    v_add_f32 v45, v54, v66
    v_add_f32 v46, v56, v68
    v_add_f32 v47, v57, v69
    v_cvt_pk_bf16_f32 v48, v40, v41
    v_cvt_pk_bf16_f32 v49, v42, v43
    v_cvt_pk_bf16_f32 v50, v44, v45
    v_cvt_pk_bf16_f32 v51, v46, v47
    ds_write_b128 v246, v[48:51] offset:0
    s_cmp_lg_u32 s3, 7
    s_cbranch_scc1 X_LE
    ds_write_b32 v248, v47 offset:64
X_LE:
    s_setprio 0
X_2:
    s_cmp_lg_u32 s60, 8
    s_cbranch_scc1 X_3
    s_setprio 2
    s_mov_b32 s58, 800000
X_WS:
    ds_read_b32 v140, v15 offset:8
    s_waitcnt lgkmcnt(0)
    v_readfirstlane_b32 s57, v140
    s_sub_u32 s58, s58, 1
    s_cbranch_scc1 X_WS_X
    s_cmp_lt_u32 s57, 8
    s_cbranch_scc1 X_WS
X_WS_X:
    s_branch X_H
X_3:
    s_setprio 2
    s_xor_b32 s42, s33, 1
    s_lshl_b32 s42, s42, 15
    s_add_u32 s42, s42, 0x4000
    s_lshl_b32 s45, s39, 12
    s_add_u32 s48, s42, s45
    s_mov_b32 s58, 100000
X_QP:
    s_buffer_load_dword s52, s[8:11], s48 offset:3068 glc
    s_sub_u32 s58, s58, 1
    s_cbranch_scc1 X_QP_X
    s_waitcnt lgkmcnt(0)
    s_cmp_lg_u32 s52, s35
    s_cbranch_scc1 X_QP
X_QP_X:
    s_waitcnt lgkmcnt(0)
    buffer_load_dwordx4 v[140:143], v177, s[8:11], s42 offen offset:0 sc1
    buffer_load_dwordx4 v[144:147], v177, s[8:11], s42 offen offset:1024 sc1
    buffer_load_dwordx4 v[148:151], v177, s[8:11], s42 offen offset:2048 sc1
    s_mov_b32 s58, 800000
X_WO:
    ds_read_b32 v48, v15 offset:12
    s_waitcnt lgkmcnt(0)
    v_readfirstlane_b32 s57, v48
    s_sub_u32 s58, s58, 1
    s_cbranch_scc1 X_WO_X
    s_cmp_lt_u32 s57, 4
    s_cbranch_scc1 X_WO
X_WO_X:
    v_subrev_u32 v152, 81920, v176
    ds_read_b128 v[48:51], v152 offset:0
    ds_read_b128 v[52:55], v152 offset:1024
    ds_read_b128 v[56:59], v152 offset:20480
    ds_read_b128 v[60:63], v152 offset:21504
    ds_read_b128 v[64:67], v152 offset:40960
    ds_read_b128 v[68:71], v152 offset:41984
    ds_read_b128 v[72:75], v152 offset:61440
    ds_read_b128 v[76:79], v152 offset:62464
    s_waitcnt lgkmcnt(4)
    v_pk_add_f32 v[48:49], v[48:49], v[56:57]
    v_pk_add_f32 v[50:51], v[50:51], v[58:59]
    v_pk_add_f32 v[52:53], v[52:53], v[60:61]
    v_pk_add_f32 v[54:55], v[54:55], v[62:63]
    s_waitcnt lgkmcnt(0)
    v_pk_add_f32 v[64:65], v[64:65], v[72:73]
    v_pk_add_f32 v[66:67], v[66:67], v[74:75]
    v_pk_add_f32 v[68:69], v[68:69], v[76:77]
    v_pk_add_f32 v[70:71], v[70:71], v[78:79]
    v_pk_add_f32 v[40:41], v[48:49], v[64:65]
    v_pk_add_f32 v[42:43], v[50:51], v[66:67]
    v_pk_add_f32 v[44:45], v[52:53], v[68:69]
    v_pk_add_f32 v[46:47], v[54:55], v[70:71]
    s_waitcnt vmcnt(0)
    v_cmp_ne_u32 vcc, s35, v143
    v_cmp_ne_u32 s[56:57], s35, v147
    s_or_b64 vcc, vcc, s[56:57]
    v_cmp_ne_u32 s[56:57], s35, v151
    s_or_b64 vcc, vcc, s[56:57]
    s_cbranch_vccz X_OK
    s_mov_b32 s58, 100000
X_PP:
    buffer_load_dwordx4 v[140:143], v177, s[8:11], s42 offen offset:0 sc1
    buffer_load_dwordx4 v[144:147], v177, s[8:11], s42 offen offset:1024 sc1
    buffer_load_dwordx4 v[148:151], v177, s[8:11], s42 offen offset:2048 sc1
    s_waitcnt vmcnt(0)
    v_cmp_ne_u32 vcc, s35, v143
    v_cmp_ne_u32 s[56:57], s35, v147
    s_or_b64 vcc, vcc, s[56:57]
    v_cmp_ne_u32 s[56:57], s35, v151
    s_or_b64 vcc, vcc, s[56:57]
    s_sub_u32 s58, s58, 1
    s_cbranch_scc1 X_PP_X
    s_cbranch_vccnz X_PP
X_PP_X:
X_OK:
    v_add_f32 v40, v40, v140
    v_add_f32 v41, v41, v141
    v_add_f32 v42, v42, v142
    v_add_f32 v43, v43, v144
    v_add_f32 v44, v44, v145
    v_add_f32 v45, v45, v146
    v_add_f32 v46, v46, v148
    v_add_f32 v47, v47, v149
    v_cvt_pk_bf16_f32 v48, v40, v41
    v_cvt_pk_bf16_f32 v49, v42, v43
    v_cvt_pk_bf16_f32 v50, v44, v45
    v_cvt_pk_bf16_f32 v51, v46, v47
    ds_write_b128 v246, v[48:51] offset:4096
    s_cmp_lg_u32 s3, 7
    s_cbranch_scc1 X_LO
    ds_write_b32 v248, v47 offset:320
X_LO:
FINAL:
    s_cmp_ge_u32 s33, 250
    s_cbranch_scc1 FIN_X
    s_mov_b64 s[56:57], -1
    s_mov_b32 s48, 0xffff0000
    s_waitcnt vmcnt(0)
    v_lshlrev_b32 v128, 16, v32
    v_and_b32 v129, s48, v32
    v_lshlrev_b32 v130, 16, v33
    v_and_b32 v131, s48, v33
    v_lshlrev_b32 v132, 16, v34
    v_and_b32 v133, s48, v34
    v_lshlrev_b32 v134, 16, v35
    v_and_b32 v135, s48, v35
F_SYNC:
    s_waitcnt lgkmcnt(0)
    s_barrier
    ds_read_b32 v120, v251 offset:320
    ds_read_b32 v121, v251 offset:64
    ds_read_b32 v122, v249
    ds_read_b128 v[40:43], v250
    ds_read_b128 v[44:47], v250 offset:2048
    ds_read_b128 v[112:115], v1
    ds_read_b128 v[116:119], v1 offset:64
    s_waitcnt lgkmcnt(4)
    v_cndmask_b32 v121, v120, v121, s[54:55]
    v_rcp_f32 v122, v122
    v_subrev_u32 v120, 0x1f800000, v120
    v_subrev_u32 v121, 0x1f800000, v121
    v_max_u32 v120, v120, v121
    v_cmp_lt_u32 vcc, 0x52000000, v120
    s_waitcnt lgkmcnt(2)
    v_mfma_f32_16x16x32_bf16 v[104:107], v[224:227], v[40:43], 0
    v_mfma_f32_16x16x32_bf16 v[108:111], v[228:231], v[40:43], 0
    v_mfma_f32_16x16x32_bf16 v[104:107], v[232:235], v[44:47], v[104:107]
    v_mfma_f32_16x16x32_bf16 v[108:111], v[236:239], v[44:47], v[108:111]
    s_waitcnt lgkmcnt(0)
    v_mfma_f32_16x16x32_bf16 v[96:99], v[208:211], v[112:115], 0
    v_mfma_f32_16x16x32_bf16 v[100:103], v[212:215], v[112:115], 0
    v_mfma_f32_16x16x32_bf16 v[96:99], v[216:219], v[116:119], v[96:99]
    v_mfma_f32_16x16x32_bf16 v[100:103], v[220:223], v[116:119], v[100:103]
    s_and_b64 vcc, vcc, s[56:57]
    s_cbranch_scc1 F_FB
    s_nop 5
    v_pk_fma_f32 v[96:97], v[104:105], v[122:123], v[96:97] op_sel_hi:[1,0,1]
    v_pk_fma_f32 v[98:99], v[106:107], v[122:123], v[98:99] op_sel_hi:[1,0,1]
    v_pk_fma_f32 v[100:101], v[108:109], v[122:123], v[100:101] op_sel_hi:[1,0,1]
    v_pk_fma_f32 v[102:103], v[110:111], v[122:123], v[102:103] op_sel_hi:[1,0,1]
    v_cvt_pk_bf16_f32 v48, v96, v97
    v_cvt_pk_bf16_f32 v49, v98, v99
    v_cvt_pk_bf16_f32 v50, v100, v101
    v_cvt_pk_bf16_f32 v51, v102, v103
    v_lshlrev_b32 v40, 16, v48
    v_and_b32 v41, s48, v48
    v_lshlrev_b32 v42, 16, v49
    v_and_b32 v43, s48, v49
    v_lshlrev_b32 v44, 16, v50
    v_and_b32 v45, s48, v50
    v_lshlrev_b32 v46, 16, v51
    v_and_b32 v47, s48, v51
    v_pk_add_f32 v[40:41], v[40:41], v[128:129]
    v_pk_add_f32 v[42:43], v[42:43], v[130:131]
    v_pk_add_f32 v[44:45], v[44:45], v[132:133]
    v_pk_add_f32 v[46:47], v[46:47], v[134:135]
    v_cvt_pk_bf16_f32 v48, v40, v41
    v_cvt_pk_bf16_f32 v49, v42, v43
    v_cvt_pk_bf16_f32 v50, v44, v45
    v_cvt_pk_bf16_f32 v51, v46, v47
    buffer_store_dwordx4 v[48:51], v12, s[24:27], 0 offen
FIN_X:
END:
    s_endpgm
F_FB:
    s_nop 7
    s_barrier
    s_mov_b64 s[56:57], 0
    s_mov_b32 s8, s4
    s_mov_b32 s9, s5
    s_mov_b32 s10, 0x138800
    s_mov_b32 s11, 0x20000
    s_lshr_b32 s42, s3, 2
    s_lshl_b32 s43, s42, 12
    s_add_u32 s43, s43, 118784
    v_add_u32 v41, s43, v11
    ds_read_b128 v[192:195], v41 offset:0
    ds_read_b128 v[196:199], v41 offset:1024
    ds_read_b128 v[200:203], v41 offset:2048
    ds_read_b128 v[204:207], v41 offset:3072
    s_lshl_b32 s36, s3, 12
    v_and_b32 v41, 2, v0
    v_lshlrev_b32 v41, 1, v41
    v_bfe_u32 v42, v0, 2, 2
    v_and_b32 v42, 2, v42
    v_or_b32 v41, v41, v42
    v_lshrrev_b32 v42, 5, v0
    v_xor_b32 v41, v41, v42
    v_and_b32 v42, 31, v0
    v_lshlrev_b32 v42, 7, v42
    v_lshl_add_u32 v41, v41, 4, v42
    v_add_u32 v2, s36, v41
    v_xor_b32 v3, 32, v2
    v_xor_b32 v4, 64, v2
    v_xor_b32 v5, 96, v2
    v_lshrrev_b32 v41, 5, v0
    v_bfe_u32 v42, v0, 2, 2
    v_lshl_add_u32 v6, v41, 3, v42
    v_lshlrev_b32 v6, 7, v6
    v_bfe_u32 v42, v0, 4, 1
    v_xor_b32 v41, v41, v42
    v_lshl_add_u32 v6, v41, 5, v6
    v_bfe_u32 v41, v0, 3, 1
    v_lshl_add_u32 v6, v41, 6, v6
    v_and_b32 v41, 3, v0
    v_lshl_add_u32 v6, v41, 3, v6
    v_add_u32 v6, s36, v6
    v_xor_b32 v7, 0, v6
    v_add_u32 v7, 0x200, v7
    v_xor_b32 v8, 64, v6
    v_xor_b32 v9, 64, v7
    v_mov_b32 v10, 0xdddddddd
    v_and_b32 v41, 16, v0
    v_lshlrev_b32 v41, 2, v41
    v_xor_b32 v242, v41, v11
    v_xor_b32 v243, 32, v242
    s_mov_b32 m0, s36
    v_mov_b32 v40, 0xff800000
    v_cmp_lt_u32 vcc, 31, v0
    s_waitcnt lgkmcnt(0)
    v_and_b32 v41, 0xffff, v207
    v_cndmask_b32 v207, v207, v41, vcc
    s_lshl_b32 s37, s39, 12
F_P0:
    buffer_load_dwordx4 v242, s[8:11], s37 offen offset:0 sc1 lds
    buffer_load_dwordx4 v243, s[8:11], s37 offen offset:1024 sc1 lds
    buffer_load_dwordx4 v242, s[8:11], s37 offen offset:2048 sc1 lds
    buffer_load_dwordx4 v243, s[8:11], s37 offen offset:3072 sc1 lds
    s_waitcnt vmcnt(0)
    ds_read_b128 v[64:67], v2 offset:0
    ds_read_b128 v[68:71], v3 offset:0
    ds_read_b128 v[72:75], v4 offset:0
    ds_read_b128 v[76:79], v5 offset:0
    s_waitcnt lgkmcnt(0)
    v_mfma_f32_32x32x16_bf16 v[16:31], v[64:67], v[192:195], 0
    v_mfma_f32_32x32x16_bf16 v[16:31], v[68:71], v[196:199], v[16:31]
    v_mfma_f32_32x32x16_bf16 v[16:31], v[72:75], v[200:203], v[16:31]
    v_mfma_f32_32x32x16_bf16 v[16:31], v[76:79], v[204:207], v[16:31]
    s_nop 7
    s_nop 7
    s_cmp_eq_u32 s37, 1277952
    v_max3_f32 v40, v40, v16, v17
    v_max3_f32 v40, v40, v18, v19
    v_max3_f32 v40, v40, v20, v21
    v_max3_f32 v40, v40, v22, v23
    s_cbranch_scc1 F_S0
    v_max3_f32 v40, v40, v24, v25
    v_max3_f32 v40, v40, v26, v27
    v_max3_f32 v40, v40, v28, v29
    v_max3_f32 v40, v40, v30, v31
F_S0:
    s_add_u32 s37, s37, 0x4000
    s_cmp_lt_u32 s37, 1282048
    s_cbranch_scc1 F_P0
    v_mov_b32 v41, v40
    v_mov_b32 v42, v40
    s_lshl_b32 s43, s3, 8
    s_add_u32 s43, s43, 0x10000
    v_permlane32_swap_b32 v41, v42
    s_nop 1
    v_max_f32 v40, v41, v42
    v_lshl_add_u32 v41, v0, 2, s43
    ds_write_b32 v41, v40
    s_and_b32 s43, s43, 0x10400
    v_lshl_add_u32 v41, v0, 2, s43
    s_waitcnt lgkmcnt(0)
    s_barrier
    ds_read_b32 v48, v41 offset:0
    ds_read_b32 v49, v41 offset:256
    ds_read_b32 v50, v41 offset:512
    ds_read_b32 v51, v41 offset:768
    v_mov_b32 v96, 0
    v_mov_b32 v97, 0
    v_mov_b32 v98, 0
    v_mov_b32 v99, 0
    v_mov_b32 v100, 0
    v_mov_b32 v101, 0
    v_mov_b32 v102, 0
    v_mov_b32 v103, 0
    v_mov_b32 v104, 0
    v_mov_b32 v105, 0
    v_mov_b32 v106, 0
    v_mov_b32 v107, 0
    v_mov_b32 v108, 0
    v_mov_b32 v109, 0
    v_mov_b32 v110, 0
    v_mov_b32 v111, 0
    v_mov_b32 v112, 0
    v_mov_b32 v113, 0
    v_mov_b32 v114, 0
    v_mov_b32 v115, 0
    v_mov_b32 v116, 0
    v_mov_b32 v117, 0
    v_mov_b32 v118, 0
    v_mov_b32 v119, 0
    v_mov_b32 v120, 0
    v_mov_b32 v121, 0
    v_mov_b32 v122, 0
    v_mov_b32 v123, 0
    v_mov_b32 v124, 0
    v_mov_b32 v125, 0
    v_mov_b32 v126, 0
    v_mov_b32 v127, 0
    s_waitcnt lgkmcnt(0)
    v_max3_f32 v40, v48, v49, v50
    v_max_f32 v40, v40, v51
    v_sub_f32 v48, 0, v40
    v_sub_f32 v49, 0, v40
    v_sub_f32 v50, 0, v40
    v_sub_f32 v51, 0, v40
    v_sub_f32 v52, 0, v40
    v_sub_f32 v53, 0, v40
    v_sub_f32 v54, 0, v40
    v_sub_f32 v55, 0, v40
    v_sub_f32 v56, 0, v40
    v_sub_f32 v57, 0, v40
    v_sub_f32 v58, 0, v40
    v_sub_f32 v59, 0, v40
    v_sub_f32 v60, 0, v40
    v_sub_f32 v61, 0, v40
    v_sub_f32 v62, 0, v40
    v_sub_f32 v63, 0, v40
    s_lshl_b32 s37, s39, 12
F_P1:
    buffer_load_dwordx4 v242, s[8:11], s37 offen offset:0 sc1 lds
    buffer_load_dwordx4 v243, s[8:11], s37 offen offset:1024 sc1 lds
    buffer_load_dwordx4 v242, s[8:11], s37 offen offset:2048 sc1 lds
    buffer_load_dwordx4 v243, s[8:11], s37 offen offset:3072 sc1 lds
    s_waitcnt vmcnt(0)
    ds_read_b128 v[64:67], v2 offset:0
    ds_read_b128 v[68:71], v3 offset:0
    ds_read_b128 v[72:75], v4 offset:0
    ds_read_b128 v[76:79], v5 offset:0
    ds_read_b64_tr_b16 v[80:81], v6 offset:0
    ds_read_b64_tr_b16 v[82:83], v7 offset:0
    ds_read_b64_tr_b16 v[84:85], v8 offset:0
    ds_read_b64_tr_b16 v[86:87], v9 offset:0
    ds_read_b64_tr_b16 v[88:89], v6 offset:2048
    ds_read_b64_tr_b16 v[90:91], v7 offset:2048
    ds_read_b64_tr_b16 v[92:93], v8 offset:2048
    ds_read_b64_tr_b16 v[94:95], v9 offset:2048
    s_waitcnt lgkmcnt(0)
    v_mfma_f32_32x32x16_bf16 v[16:31], v[64:67], v[192:195], v[48:63]
    v_mfma_f32_32x32x16_bf16 v[16:31], v[68:71], v[196:199], v[16:31]
    v_mfma_f32_32x32x16_bf16 v[16:31], v[72:75], v[200:203], v[16:31]
    v_mfma_f32_32x32x16_bf16 v[16:31], v[76:79], v[204:207], v[16:31]
    s_nop 7
    s_nop 7
    s_cmp_eq_u32 s37, 1277952
    v_exp_f32 v16, v16
    v_exp_f32 v17, v17
    v_exp_f32 v18, v18
    v_exp_f32 v19, v19
    v_exp_f32 v20, v20
    v_exp_f32 v21, v21
    v_exp_f32 v22, v22
    v_exp_f32 v23, v23
    s_nop 2
    v_smfmac_f32_32x32x32_bf16 v[96:111], v[80:83], v[16:23], v10
    v_smfmac_f32_32x32x32_bf16 v[112:127], v[84:87], v[16:23], v10
    s_cbranch_scc1 F_S1
    v_exp_f32 v24, v24
    v_exp_f32 v25, v25
    v_exp_f32 v26, v26
    v_exp_f32 v27, v27
    v_exp_f32 v28, v28
    v_exp_f32 v29, v29
    v_exp_f32 v30, v30
    v_exp_f32 v31, v31
    s_nop 2
    v_smfmac_f32_32x32x32_bf16 v[96:111], v[88:91], v[24:31], v10
    v_smfmac_f32_32x32x32_bf16 v[112:127], v[92:95], v[24:31], v10
F_S1:
    s_add_u32 s37, s37, 0x4000
    s_cmp_lt_u32 s37, 1282048
    s_cbranch_scc1 F_P1
    s_mul_i32 s42, s39, 20480
    s_lshl_b32 s43, s39, 13
    s_add_u32 s43, s43, 90112
    s_cmp_ge_u32 s3, 4
    s_cselect_b32 s42, s43, s42
    v_add_u32 v92, s42, v11
    s_cselect_b32 s42, 0x2000, 0
    v_add_u32 v41, s42, v92
    s_nop 7
    s_nop 7
    s_barrier
    ds_write_b128 v41, v[96:99] offset:0
    ds_write_b128 v41, v[100:103] offset:1024
    ds_write_b128 v41, v[104:107] offset:2048
    ds_write_b128 v41, v[108:111] offset:3072
    ds_write_b128 v41, v[112:115] offset:4096
    ds_write_b128 v41, v[116:119] offset:5120
    ds_write_b128 v41, v[120:123] offset:6144
    ds_write_b128 v41, v[124:127] offset:7168
    s_waitcnt lgkmcnt(0)
    s_barrier
    s_cmp_lt_u32 s3, 4
    s_cbranch_scc1 F_SYNC
    ds_read_b128 v[48:51], v176 offset:16384
    ds_read_b128 v[52:55], v176 offset:17408
    ds_read_b128 v[56:59], v176 offset:24576
    ds_read_b128 v[60:63], v176 offset:25600
    ds_read_b128 v[64:67], v176 offset:32768
    ds_read_b128 v[68:71], v176 offset:33792
    ds_read_b128 v[72:75], v176 offset:40960
    ds_read_b128 v[76:79], v176 offset:41984
    s_waitcnt lgkmcnt(0)
    v_pk_add_f32 v[48:49], v[48:49], v[56:57]
    v_pk_add_f32 v[64:65], v[64:65], v[72:73]
    v_pk_add_f32 v[50:51], v[50:51], v[58:59]
    v_pk_add_f32 v[66:67], v[66:67], v[74:75]
    v_pk_add_f32 v[52:53], v[52:53], v[60:61]
    v_pk_add_f32 v[68:69], v[68:69], v[76:77]
    v_pk_add_f32 v[54:55], v[54:55], v[62:63]
    v_pk_add_f32 v[70:71], v[70:71], v[78:79]
    v_pk_add_f32 v[40:41], v[48:49], v[64:65]
    v_pk_add_f32 v[42:43], v[50:51], v[66:67]
    v_pk_add_f32 v[44:45], v[52:53], v[68:69]
    v_pk_add_f32 v[46:47], v[54:55], v[70:71]
    v_cvt_pk_bf16_f32 v48, v40, v41
    v_cvt_pk_bf16_f32 v49, v42, v43
    v_cvt_pk_bf16_f32 v50, v44, v45
    v_cvt_pk_bf16_f32 v51, v46, v47
    ds_write_b128 v246, v[48:51] offset:0
    s_cmp_lg_u32 s3, 7
    s_cbranch_scc1 F_LE
    ds_write_b32 v248, v47 offset:64
F_LE:
    v_subrev_u32 v152, 81920, v176
    ds_read_b128 v[48:51], v152 offset:0
    ds_read_b128 v[52:55], v152 offset:1024
    ds_read_b128 v[56:59], v152 offset:20480
    ds_read_b128 v[60:63], v152 offset:21504
    ds_read_b128 v[64:67], v152 offset:40960
    ds_read_b128 v[68:71], v152 offset:41984
    ds_read_b128 v[72:75], v152 offset:61440
    ds_read_b128 v[76:79], v152 offset:62464
    s_waitcnt lgkmcnt(4)
    v_pk_add_f32 v[48:49], v[48:49], v[56:57]
    v_pk_add_f32 v[50:51], v[50:51], v[58:59]
    v_pk_add_f32 v[52:53], v[52:53], v[60:61]
    v_pk_add_f32 v[54:55], v[54:55], v[62:63]
    s_waitcnt lgkmcnt(0)
    v_pk_add_f32 v[64:65], v[64:65], v[72:73]
    v_pk_add_f32 v[66:67], v[66:67], v[74:75]
    v_pk_add_f32 v[68:69], v[68:69], v[76:77]
    v_pk_add_f32 v[70:71], v[70:71], v[78:79]
    v_pk_add_f32 v[40:41], v[48:49], v[64:65]
    v_pk_add_f32 v[42:43], v[50:51], v[66:67]
    v_pk_add_f32 v[44:45], v[52:53], v[68:69]
    v_pk_add_f32 v[46:47], v[54:55], v[70:71]
    v_cvt_pk_bf16_f32 v48, v40, v41
    v_cvt_pk_bf16_f32 v49, v42, v43
    v_cvt_pk_bf16_f32 v50, v44, v45
    v_cvt_pk_bf16_f32 v51, v46, v47
    ds_write_b128 v246, v[48:51] offset:4096
    s_cmp_lg_u32 s3, 7
    s_cbranch_scc1 F_LO
    ds_write_b32 v248, v47 offset:320
F_LO:
    s_branch F_SYNC
X_H:
    s_setprio 2
    ds_read_b128 v[140:143], v176 offset:0
    ds_read_b128 v[144:147], v176 offset:1024
    ds_read_b128 v[148:151], v176 offset:8192
    ds_read_b128 v[152:155], v176 offset:9216
    ds_read_b128 v[156:159], v176 offset:16384
    ds_read_b128 v[160:163], v176 offset:17408
    ds_read_b128 v[164:167], v176 offset:24576
    ds_read_b128 v[168:171], v176 offset:25600
    s_mov_b64 exec, 1
    ds_add_u32 v15, v6 offset:20
    s_mov_b64 exec, -1
    s_sub_u32 s44, s60, 4
    s_lshl_b32 s42, s33, 15
    s_mul_i32 s43, s44, 0x1000
    s_add_u32 s42, s42, s43
    s_waitcnt lgkmcnt(5)
    v_add_f32 v140, v140, v148
    v_add_f32 v141, v141, v149
    v_add_f32 v142, v142, v150
    v_add_f32 v143, v143, v151
    v_add_f32 v144, v144, v152
    v_add_f32 v145, v145, v153
    v_add_f32 v146, v146, v154
    v_add_f32 v147, v147, v155
    s_waitcnt lgkmcnt(1)
    v_add_f32 v156, v156, v164
    v_add_f32 v157, v157, v165
    v_add_f32 v158, v158, v166
    v_add_f32 v159, v159, v167
    v_add_f32 v160, v160, v168
    v_add_f32 v161, v161, v169
    v_add_f32 v162, v162, v170
    v_add_f32 v163, v163, v171
    v_add_f32 v180, v140, v156
    v_add_f32 v181, v141, v157
    v_add_f32 v182, v142, v158
    buffer_store_dwordx4 v[180:183], v177, s[8:11], s42 offen offset:0 sc1
    v_add_f32 v184, v143, v159
    v_add_f32 v185, v144, v160
    v_add_f32 v186, v145, v161
    buffer_store_dwordx4 v[184:187], v177, s[8:11], s42 offen offset:1024 sc1
    v_add_f32 v188, v146, v162
    v_add_f32 v189, v147, v163
    buffer_store_dwordx4 v[188:191], v177, s[8:11], s42 offen offset:2048 sc1
    s_cmp_lg_u32 s60, 4
    s_cbranch_scc1 X_H1
    v_mov_b32 v192, v180
    v_mov_b32 v193, v181
    v_mov_b32 v194, v182
    v_mov_b32 v195, v184
    v_mov_b32 v196, v185
    v_mov_b32 v197, v186
    v_mov_b32 v198, v188
    v_mov_b32 v199, v189
X_H1:
    s_add_u32 s60, s60, 4
    s_setprio 0
    s_cmp_eq_u32 s61, 0
    s_cbranch_scc1 G_RET
    s_branch X_D
G_SLOW:
    s_waitcnt vmcnt(0) lgkmcnt(0)
    s_mov_b64 exec, 1
    ds_add_u32 v15, v6 offset:16
    s_mov_b64 exec, -1
    s_mov_b32 s58, 800000
G_S2:
    ds_read_b32 v239, v15 offset:16
    s_waitcnt lgkmcnt(0)
    v_readfirstlane_b32 s57, v239
    s_sub_u32 s58, s58, 1
    s_cbranch_scc1 G_S2_X
    s_cmp_lt_u32 s57, 4
    s_cbranch_scc1 G_S2
G_S2_X:
    v_add_u32 v238, 138176, v3
    v_mov_b32 v108, 0
    v_mov_b32 v109, 0
    v_mov_b32 v110, 0
    v_mov_b32 v111, 0
    ds_write_b128 v238, v[108:111] offset:0
    ds_write_b128 v238, v[108:111] offset:4096
    ds_write_b128 v238, v[108:111] offset:8192
    s_waitcnt lgkmcnt(0)
    s_mov_b64 exec, 1
    ds_add_u32 v15, v6 offset:16
    s_mov_b64 exec, -1
    s_mov_b32 s58, 800000
G_S3:
    ds_read_b32 v239, v15 offset:16
    s_waitcnt lgkmcnt(0)
    v_readfirstlane_b32 s57, v239
    s_sub_u32 s58, s58, 1
    s_cbranch_scc1 G_S3_X
    s_cmp_lt_u32 s57, 8
    s_cbranch_scc1 G_S3
G_S3_X:
    s_mov_b32 s48, s4
    s_mov_b32 s49, s5
    s_mov_b32 s50, 0x138800
    s_mov_b32 s51, 0x20000
    v_lshlrev_b32 v238, 2, v0
    v_lshlrev_b32 v239, 1, v0
    v_add_u32 v242, 138176, v238
    s_mul_i32 s42, s33, 40
    s_mov_b64 s[44:45], 0
    v_cmp_lt_u32 vcc, 1, v244
    s_and_b32 vcc_lo, vcc_lo, 0x11111111
    s_and_b32 vcc_hi, vcc_hi, 0x11111111
    s_or_b64 s[44:45], s[44:45], vcc
    v_cmp_lt_u32 vcc, 1, v245
    s_and_b32 vcc_lo, vcc_lo, 0x22222222
    s_and_b32 vcc_hi, vcc_hi, 0x22222222
    s_or_b64 s[44:45], s[44:45], vcc
    v_cmp_lt_u32 vcc, 1, v246
    s_and_b32 vcc_lo, vcc_lo, 0x44444444
    s_and_b32 vcc_hi, vcc_hi, 0x44444444
    s_or_b64 s[44:45], s[44:45], vcc
    v_cmp_lt_u32 vcc, 1, v247
    s_and_b32 vcc_lo, vcc_lo, 0x88888888
    s_and_b32 vcc_hi, vcc_hi, 0x88888888
    s_or_b64 s[44:45], s[44:45], vcc
G_SC:
    s_cmp_eq_u64 s[44:45], 0
    s_cbranch_scc1 G_SE
    s_ff1_i32_b64 s43, s[44:45]
    s_bitset0_b64 s[44:45], s43
    s_and_b32 s47, s43, 3
    s_lshr_b32 s43, s43, 2
    s_lshl2_add_u32 s47, s39, s47
    s_lshl4_add_u32 s43, s47, s43
    s_mul_i32 s43, s43, 10240
    s_add_u32 s47, s43, 10240
G_SS:
    buffer_load_dword v108, v238, s[20:23], s43 offen
    buffer_load_dword v109, v238, s[24:27], s43 offen
    s_waitcnt vmcnt(0)
    v_subrev_u32 v108, s42, v108
    v_cmp_gt_u32 s[52:53], 40, v108
G_SI:
    s_cmp_eq_u64 s[52:53], 0
    s_cbranch_scc1 G_SN
    s_ff1_i32_b64 s56, s[52:53]
    s_bitset0_b64 s[52:53], s56
    v_readlane_b32 s57, v109, s56
    v_readlane_b32 s58, v108, s56
    s_lshl_b32 s57, s57, 7
    s_lshl_b32 s58, s58, 8
    buffer_load_ushort v110, v239, s[48:51], s57 offen sc1
    v_add_u32 v111, s58, v242
    s_waitcnt vmcnt(0)
    v_lshlrev_b32 v110, 16, v110
    ds_add_f32 v111, v110
    s_waitcnt lgkmcnt(0)
    s_branch G_SI
G_SN:
    s_add_u32 s43, s43, 256
    s_cmp_lt_u32 s43, s47
    s_cbranch_scc1 G_SS
    s_branch G_SC
G_SE:
    s_mov_b64 exec, 1
    ds_add_u32 v15, v6 offset:16
    s_mov_b64 exec, -1
    s_mov_b32 s58, 800000
G_S4:
    ds_read_b32 v239, v15 offset:16
    s_waitcnt lgkmcnt(0)
    v_readfirstlane_b32 s57, v239
    s_sub_u32 s58, s58, 1
    s_cbranch_scc1 G_S4_X
    s_cmp_lt_u32 s57, 12
    s_cbranch_scc1 G_S4
G_S4_X:
    s_mul_i32 s43, s39, 2560
    s_add_u32 s43, s43, 138176
    v_lshl_add_u32 v238, v241, 1, s43
    ds_read_b128 v[108:111], v238 offset:0
    ds_read_b128 v[116:119], v238 offset:1024
    ds_read_b128 v[124:127], v238 offset:2048
    s_waitcnt lgkmcnt(0)
    s_branch G_FIN
HELP:
    s_load_dwordx2 s[8:9], s[0:1], 32
    s_load_dwordx4 s[28:31], s[0:1], 56
    v_and_b32 v1, 31, v0
    v_lshrrev_b32 v2, 5, v0
    v_and_b32 v3, 0x13, v1
    v_and_b32 v4, 4, v1
    v_lshl_or_b32 v3, v4, 1, v3
    v_and_b32 v4, 8, v1
    v_lshrrev_b32 v4, 1, v4
    v_or_b32 v3, v3, v4
    s_lshr_b32 s36, s3, 2
    s_bfe_u32 s37, s3, 0x10001
    s_and_b32 s38, s3, 1
    s_cmp_eq_u32 s36, 0
    s_cselect_b64 vcc, -1, 0
    s_movk_i32 s39, 8064
    v_cndmask_b32 v4, v1, v3, vcc
    v_lshlrev_b32 v4, 7, v4
    v_lshl_add_u32 v4, v2, 4, v4
    v_lshlrev_b32 v5, 4, v2
    s_lshl_b32 s40, s37, 12
    v_lshlrev_b32 v6, 10, v2
    v_lshl_add_u32 v6, v3, 1, v6
    s_lshl_b32 s41, s38, 6
    s_add_u32 s42, s41, 0x1000
    s_waitcnt lgkmcnt(0)
    s_add_u32 s12, s4, 0x290000
    s_addc_u32 s13, s5, 0
    s_mov_b32 s14, 0x14000
    s_mov_b32 s15, 0x20000
    s_cmp_eq_u32 s36, 0
    s_cselect_b32 s48, s8, s28
    s_cselect_b32 s49, s9, s29
    s_mov_b32 s50, 8192
    s_mov_b32 s51, 0x20000
    s_mov_b32 s20, s30
    s_mov_b32 s21, s31
    s_mov_b32 s22, 0x2000
    s_mov_b32 s23, 0x20000
    s_add_u32 s24, s4, 0x280000
    s_addc_u32 s25, s5, 0
    s_mov_b32 s26, 0x4000
    s_mov_b32 s27, 0x20000
    buffer_load_dwordx4 v[16:19], v4, s[48:51], s40 offen offset:0
    buffer_load_dwordx4 v[32:35], v5, s[48:51], s39 offen offset:0
    buffer_load_dwordx4 v[20:23], v4, s[48:51], s40 offen offset:32
    buffer_load_dwordx4 v[36:39], v5, s[48:51], s39 offen offset:32
    buffer_load_dwordx4 v[24:27], v4, s[48:51], s40 offen offset:64
    buffer_load_dwordx4 v[40:43], v5, s[48:51], s39 offen offset:64
    buffer_load_dwordx4 v[28:31], v4, s[48:51], s40 offen offset:96
    buffer_load_dwordx4 v[44:47], v5, s[48:51], s39 offen offset:96
    buffer_load_ushort v48, v6, s[20:23], s41 offen offset:0
    buffer_load_ushort v49, v6, s[20:23], s41 offen offset:256
    buffer_load_ushort v50, v6, s[20:23], s41 offen offset:512
    buffer_load_ushort v51, v6, s[20:23], s41 offen offset:768
    buffer_load_ushort v52, v6, s[20:23], s41 offen offset:2048
    buffer_load_ushort v53, v6, s[20:23], s41 offen offset:2304
    buffer_load_ushort v54, v6, s[20:23], s41 offen offset:2560
    buffer_load_ushort v55, v6, s[20:23], s41 offen offset:2816
    buffer_load_ushort v56, v6, s[20:23], s42 offen offset:0
    buffer_load_ushort v57, v6, s[20:23], s42 offen offset:256
    buffer_load_ushort v58, v6, s[20:23], s42 offen offset:512
    buffer_load_ushort v59, v6, s[20:23], s42 offen offset:768
    buffer_load_ushort v60, v6, s[20:23], s42 offen offset:2048
    buffer_load_ushort v61, v6, s[20:23], s42 offen offset:2304
    buffer_load_ushort v62, v6, s[20:23], s42 offen offset:2560
    buffer_load_ushort v63, v6, s[20:23], s42 offen offset:2816
    buffer_load_ushort v80, v6, s[20:23], s41 offen offset:128
    buffer_load_ushort v81, v6, s[20:23], s41 offen offset:384
    buffer_load_ushort v82, v6, s[20:23], s41 offen offset:640
    buffer_load_ushort v83, v6, s[20:23], s41 offen offset:896
    buffer_load_ushort v84, v6, s[20:23], s41 offen offset:2176
    buffer_load_ushort v85, v6, s[20:23], s41 offen offset:2432
    buffer_load_ushort v86, v6, s[20:23], s41 offen offset:2688
    buffer_load_ushort v87, v6, s[20:23], s41 offen offset:2944
    buffer_load_ushort v88, v6, s[20:23], s42 offen offset:128
    buffer_load_ushort v89, v6, s[20:23], s42 offen offset:384
    buffer_load_ushort v90, v6, s[20:23], s42 offen offset:640
    buffer_load_ushort v91, v6, s[20:23], s42 offen offset:896
    buffer_load_ushort v92, v6, s[20:23], s42 offen offset:2176
    buffer_load_ushort v93, v6, s[20:23], s42 offen offset:2432
    buffer_load_ushort v94, v6, s[20:23], s42 offen offset:2688
    buffer_load_ushort v95, v6, s[20:23], s42 offen offset:2944
    s_waitcnt vmcnt(0)
    v_lshl_or_b32 v48, v80, 16, v48
    v_lshl_or_b32 v49, v81, 16, v49
    v_lshl_or_b32 v50, v82, 16, v50
    v_lshl_or_b32 v51, v83, 16, v51
    v_lshl_or_b32 v52, v84, 16, v52
    v_lshl_or_b32 v53, v85, 16, v53
    v_lshl_or_b32 v54, v86, 16, v54
    v_lshl_or_b32 v55, v87, 16, v55
    v_lshl_or_b32 v56, v88, 16, v56
    v_lshl_or_b32 v57, v89, 16, v57
    v_lshl_or_b32 v58, v90, 16, v58
    v_lshl_or_b32 v59, v91, 16, v59
    v_lshl_or_b32 v60, v92, 16, v60
    v_lshl_or_b32 v61, v93, 16, v61
    v_lshl_or_b32 v62, v94, 16, v62
    v_lshl_or_b32 v63, v95, 16, v63
    v_xor_b32 v32, 0x80008000, v32
    v_xor_b32 v33, 0x80008000, v33
    v_xor_b32 v34, 0x80008000, v34
    v_xor_b32 v35, 0x80008000, v35
    v_xor_b32 v36, 0x80008000, v36
    v_xor_b32 v37, 0x80008000, v37
    v_xor_b32 v38, 0x80008000, v38
    v_xor_b32 v39, 0x80008000, v39
    v_xor_b32 v40, 0x80008000, v40
    v_xor_b32 v41, 0x80008000, v41
    v_xor_b32 v42, 0x80008000, v42
    v_xor_b32 v43, 0x80008000, v43
    v_xor_b32 v44, 0x80008000, v44
    v_xor_b32 v45, 0x80008000, v45
    v_xor_b32 v46, 0x80008000, v46
    v_xor_b32 v47, 0x80008000, v47
    s_nop 1
    v_mfma_f32_32x32x16_bf16 v[64:79], v[16:19], v[48:51], 0
    v_mfma_f32_32x32x16_bf16 v[64:79], v[20:23], v[52:55], v[64:79]
    v_mfma_f32_32x32x16_bf16 v[64:79], v[24:27], v[56:59], v[64:79]
    v_mfma_f32_32x32x16_bf16 v[64:79], v[28:31], v[60:63], v[64:79]
    v_mfma_f32_32x32x16_bf16 v[64:79], v[32:35], v[48:51], v[64:79]
    v_mfma_f32_32x32x16_bf16 v[64:79], v[36:39], v[52:55], v[64:79]
    v_mfma_f32_32x32x16_bf16 v[64:79], v[40:43], v[56:59], v[64:79]
    v_mfma_f32_32x32x16_bf16 v[64:79], v[44:47], v[60:63], v[64:79]
    s_lshl_b32 s43, s36, 13
    s_lshl_b32 s44, s38, 12
    s_add_u32 s43, s43, s44
    s_lshl_b32 s44, s37, 11
    s_add_u32 s43, s43, s44
    s_nop 7
    s_nop 7
    v_cvt_pk_bf16_f32 v16, v64, v65
    v_cvt_pk_bf16_f32 v17, v66, v67
    v_cvt_pk_bf16_f32 v18, v68, v69
    v_cvt_pk_bf16_f32 v19, v70, v71
    v_cvt_pk_bf16_f32 v20, v72, v73
    v_cvt_pk_bf16_f32 v21, v74, v75
    v_cvt_pk_bf16_f32 v22, v76, v77
    v_cvt_pk_bf16_f32 v23, v78, v79
    buffer_store_dwordx4 v[16:19], v11, s[24:27], s43 offen sc1
    buffer_store_dwordx4 v[20:23], v11, s[24:27], s43 offen offset:1024 sc1
    s_waitcnt vmcnt(0)
    s_waitcnt lgkmcnt(0)
    s_barrier
    s_cmp_ge_u32 s3, 4
    s_cbranch_scc1 H_B
    ds_read_b32 v16, v15
    v_lshlrev_b32 v17, 7, v0
    s_lshl_b32 s42, s3, 13
    s_add_u32 s42, s42, 32768
    s_waitcnt lgkmcnt(0)
    v_readfirstlane_b32 s35, v16
    s_cmp_eq_u32 s3, 3
    s_cselect_b32 exec_hi, 0x0fffffff, -1
    s_mov_b32 s58, 100000
H_PS:
    buffer_load_dwordx4 v[20:23], v17, s[12:15], s42 offen sc1
    s_waitcnt vmcnt(0)
    v_xor_b32 v20, s35, v20
    v_xor_b32 v21, s35, v21
    v_xor_b32 v22, s35, v22
    v_xor_b32 v23, s35, v23
    v_or3_b32 v20, v20, v21, v22
    v_or_b32 v20, v20, v23
    v_cmpx_ne_u32 vcc, 0, v20
    s_sub_u32 s58, s58, 1
    s_cbranch_scc1 H_PX
    s_cbranch_execnz H_PS
H_PX:
    s_mov_b32 exec_lo, -1
    s_mov_b32 exec_hi, 0
    v_lshlrev_b32 v17, 9, v0
    s_lshl_b32 s42, s3, 7
    s_add_u32 s42, s42, 65536
    buffer_store_dword v16, v17, s[12:15], s42 offen sc1
H_B:
    s_barrier
    s_cmp_lg_u32 s3, 0
    s_cbranch_scc1 FIN_X
    v_mov_b32 v18, 0
    s_mov_b64 exec, 1
    buffer_store_dword v18, off, s[16:19], 0 sc1
    s_mov_b64 exec, -1
    s_branch FIN_X
.section .rodata,"a"
.p2align 6
.amdhsa_kernel gather_scatter__hybrid_graph_tf_graphgps__graph_kernel
  .amdhsa_next_free_vgpr 256
  .amdhsa_next_free_sgpr 72
  .amdhsa_accum_offset 256
  .amdhsa_group_segment_fixed_size 0
  .amdhsa_kernarg_size 96
  .amdhsa_user_sgpr_count 2
  .amdhsa_user_sgpr_kernarg_segment_ptr 1
  .amdhsa_system_sgpr_workgroup_id_x 1
.end_amdhsa_kernel
```
